```python
import torch

def _softmax(x, axis=-1):
    return torch.softmax(x, dim=axis)
def _gelu(x):
    return torch.nn.functional.gelu(x, approximate="tanh")
def _silu(x):
    return torch.nn.functional.silu(x)
def _sigmoid(x):
    return torch.sigmoid(x)
def _layernorm(x, axis=-1, eps=1e-5):
    m = x.mean(dim=axis, keepdim=True)
    v = x.var(dim=axis, keepdim=True, unbiased=False)
    return (x - m) / torch.sqrt(v + eps)
def _scatter_add(tgt, idx, src, axis=0):
    return tgt.clone().index_add_(axis, idx, src)
def _segment_sum(src, seg, n):
    out = torch.zeros((n,) + src.shape[1:], dtype=src.dtype)
    return out.index_add_(0, seg, src)
def _pad(x, pw):
    flat = tuple(v for pair in reversed(pw) for v in pair)
    return torch.nn.functional.pad(x, flat)

kernel_name = 'recurrent_scan__gqa_block_cached__swiglu_ffn__decode'

def setup_inputs():

    _w = (lambda a: (lambda t: t.to(torch.bfloat16) if t.is_floating_point() else t)(torch.as_tensor(a)))
    def _A_setup():
        B, Sq, D = 8, 1, 448
        Hq, Hkv, Sk, Dh = 16, 8, 4096, 256
        assert Hq % Hkv == 0, (Hq, Hkv)
        return {
            "x": _w((lambda *s: torch.randn(*s, dtype=torch.bfloat16) * 0.05)(B, Sq, D)),
            "k_cache": _w((lambda *s: torch.randn(*s, dtype=torch.bfloat16) * 1.6)(B, Hkv, Sk, Dh)),
            "v_cache": _w((lambda *s: torch.randn(*s, dtype=torch.bfloat16) * 0.2)(B, Hkv, Sk, Dh)),
            "wq": _w((lambda *s: torch.randn(*s, dtype=torch.bfloat16) * 1.6)(D, Hq * Dh) * (D ** -0.5)),
            "wo": _w((lambda *s: torch.randn(*s, dtype=torch.bfloat16) * 0.2)(Hq * Dh, D) * ((Hq * Dh) ** -0.5)),
        }
    _A_in = _A_setup()

    def _B_setup():
        B, S, D, F = 8, 1, 448, 1792
        return {
            "x": _w((lambda *s: torch.randn(*s, dtype=torch.bfloat16) * 0.05)(B, S, D)),
            "w_gate": _w((lambda *s: torch.randn(*s, dtype=torch.bfloat16) * 0.1)(D, F)),
            "w_up": _w((lambda *s: torch.randn(*s, dtype=torch.bfloat16) * 0.1)(D, F)),
            "w_down": _w((lambda *s: torch.randn(*s, dtype=torch.bfloat16) * 0.1)(F, D)),
        }
    _B_in = _B_setup()

    return {
        "A_x": _A_in["x"],
        "A_k_cache": _A_in["k_cache"],
        "A_v_cache": _A_in["v_cache"],
        "A_wq": _A_in["wq"],
        "A_wo": _A_in["wo"],
        "B_x": _B_in["x"],
        "B_w_gate": _B_in["w_gate"],
        "B_w_up": _B_in["w_up"],
        "B_w_down": _B_in["w_down"],
    }

def reference(A_x, A_k_cache, A_v_cache, A_wq, A_wo, B_x, B_w_gate, B_w_up, B_w_down):
    def _A_ref(x, k_cache, v_cache, wq, wo):
        B, Sq, D = x.shape
        Hq, Dh = 16, 256
        Hkv = k_cache.shape[1]
        rep = Hq // Hkv
        q = (lambda x, *d: x.permute(*d))((x @ wq).reshape(B, Sq, Hq, Dh), 0, 2, 1, 3)
        k = (lambda x, n, axis: torch.repeat_interleave(x, n, dim=axis))(k_cache, rep, axis=1)
        v = (lambda x, n, axis: torch.repeat_interleave(x, n, dim=axis))(v_cache, rep, axis=1)
        scores = torch.einsum("bhqd,bhkd->bhqk", q, k) * (Dh ** -0.5)
        p = _softmax(scores, axis=-1)
        o = torch.einsum("bhqk,bhkd->bhqd", p, v)
        return (lambda x, *d: x.permute(*d))(o, 0, 2, 1, 3).reshape(B, Sq, Hq * Dh) @ wo

    def _B_ref(x, w_gate, w_up, w_down):
        g = _silu(x @ w_gate)
        u = x @ w_up
        return (g * u) @ w_down

    x = A_x
    xn = _layernorm(x, axis=-1)
    s = _A_ref(xn, A_k_cache, A_v_cache, A_wq, A_wo)
    g = _silu(_B_ref(xn, B_w_gate, B_w_up, B_w_down))
    return x + s * g
```

```asm
; @launch grid=(256,1,1) block=(256,1,1) lds=163840
.amdgcn_target "amdgcn-amd-amdhsa--gfx950"
.text
.globl recurrent_scan__gqa_block_cached__swiglu_ffn__decode_kernel
.p2align 8
.type recurrent_scan__gqa_block_cached__swiglu_ffn__decode_kernel,@function
recurrent_scan__gqa_block_cached__swiglu_ffn__decode_kernel:
  s_cmp_ge_u32 s2, 256
  s_cbranch_scc1 L_done
  s_load_dwordx4 s[4:7], s[0:1], 0
  s_load_dwordx2 s[8:9], s[0:1], 16
  s_load_dwordx4 s[12:15], s[0:1], 24
  s_load_dwordx4 s[16:19], s[0:1], 48
  s_load_dwordx4 s[20:23], s[0:1], 64
  s_load_dwordx2 s[24:25], s[0:1], 88
  v_and_b32 v1, 63, v0
  v_lshrrev_b32 v37, 6, v0
  s_and_b32 s26, s2, 7
  s_lshr_b32 s11, s2, 3
  v_readfirstlane_b32 s3, v37
  s_and_b32 s27, s11, 3
  s_lshr_b32 s10, s11, 2
  s_lshl_b32 s75, s10, 3
  s_add_u32 s75, s75, s26
  s_and_b32 s74, s2, 31
  v_lshrrev_b32 v38, 5, v1
  v_and_b32 v39, 31, v1
  s_lshl_b32 s67, s3, 1
  v_add_u32 v40, s67, v38
  v_mul_u32_u24 v41, 896, v40
  v_lshl_add_u32 v41, v39, 5, v41
  v_cmp_gt_u32 vcc, 28, v39
  v_mov_b32 v42, 0x10000000
  s_mov_b64 s[68:69], vcc
  v_cndmask_b32 v42, v42, v41, vcc
  v_xor_b32 v43, v39, v38
  v_lshlrev_b32 v43, 4, v43
  v_lshl_or_b32 v43, v38, 9, v43
  v_mov_b32 v2, v43
  v_xor_b32 v3, 32, v43
  v_xor_b32 v4, 64, v43
  v_xor_b32 v5, 96, v43
  v_xor_b32 v6, 4224, v43
  v_xor_b32 v7, 4256, v43
  v_xor_b32 v8, 4288, v43
  v_xor_b32 v9, 4320, v43
  s_mul_i32 s72, s3, 32768
  s_mov_b32 s70, 0
  s_bfe_u32 s68, s27, 0x10001
  s_lshl_b32 s68, s68, 20
  s_or_b32 s70, s70, s68
  s_bfe_u32 s68, s27, 0x10000
  s_lshl_b32 s68, s68, 15
  s_or_b32 s70, s70, s68
  s_bfe_u32 s68, s3, 0x10001
  s_lshl_b32 s68, s68, 14
  s_or_b32 s70, s70, s68
  s_bfe_u32 s68, s3, 0x10000
  s_lshl_b32 s68, s68, 13
  s_or_b32 s70, s70, s68
  s_lshl_b32 s67, s75, 21
  s_mov_b32 s66, 4294967040
  s_waitcnt lgkmcnt(0)
  s_load_dword s65, s[24:25], 0
  s_mov_b32 s52, s4
  s_and_b32 s53, s5, 0xffff
  s_mov_b32 s54, 7168
  s_mov_b32 s55, 0x20000
  buffer_load_dwordx4 v[64:67], v42, s[52:55], 0 offen
  buffer_load_dwordx4 v[68:71], v42, s[52:55], 0 offen offset:16
  s_min_u32 s68, s74, 27
  s_lshl_b32 s68, s68, 5
  s_mul_i32 s69, s10, 896
  s_add_u32 s68, s68, s69
  v_and_b32 v44, 3, v1
  v_lshlrev_b32 v44, 3, v44
  buffer_load_dwordx2 v[198:199], v44, s[52:55], s68 offen
  s_add_u32 s28, s6, s67
  s_addc_u32 s29, s7, 0
  s_and_b32 s29, s29, 0xffff
  s_mov_b32 s30, 0x200000
  s_mov_b32 s31, 0x20000
  s_add_u32 s32, s8, s67
  s_addc_u32 s33, s9, 0
  s_and_b32 s33, s33, 0xffff
  s_mov_b32 s34, 0x200000
  s_mov_b32 s35, 0x20000
  s_mov_b32 s36, s24
  s_and_b32 s37, s25, 0xffff
  s_mov_b32 s38, 8388608
  s_mov_b32 s39, 0x20000
  v_lshrrev_b32 v44, 3, v1
  v_and_b32 v45, 7, v1
  v_lshrrev_b32 v46, 4, v1
  v_lshlrev_b32 v46, 1, v46
  v_xor_b32 v45, v45, v46
  v_lshlrev_b32 v45, 4, v45
  v_mul_u32_u24 v47, 8192, v44
  v_add_u32 v47, v47, v45
  v_mul_u32_u24 v197, 3584, v44
  v_add_u32 v197, v197, v45
  s_mov_b32 s40, s12
  s_and_b32 s41, s13, 0xffff
  s_mov_b32 s42, 3670016
  s_mov_b32 s43, 0x20000
  s_mul_i32 s67, s27, 112
  s_lshl_b32 s68, s3, 3
  s_add_u32 s67, s67, s68
  s_lshl_b32 s68, s26, 10
  s_lshl_b32 s69, s10, 7
  s_add_u32 s68, s68, s69
  s_lshl_b32 s69, s67, 13
  s_add_u32 s68, s68, s69
  s_lshl_b32 s98, s3, 10
  s_add_u32 s98, s98, 131072
  s_cmp_lt_u32 s3, 2
  s_cselect_b32 s96, 12, 8
  s_add_u32 m0, s98, 0
  s_mov_b32 s99, s68
  buffer_load_dwordx4 v47, s[40:43], s99 offen  lds
  s_add_u32 m0, s98, 4096
  s_add_u32 s99, s68, 262144
  buffer_load_dwordx4 v47, s[40:43], s99 offen  lds
  s_add_u32 m0, s98, 8192
  s_add_u32 s99, s68, 524288
  buffer_load_dwordx4 v47, s[40:43], s99 offen  lds
  s_lshl_b32 s69, s96, 10
  s_add_u32 m0, s98, s69
  s_lshl_b32 s69, s96, 16
  s_add_u32 s99, s68, s69
  buffer_load_dwordx4 v47, s[40:43], s99 offen  lds
  s_waitcnt vmcnt(4)
  s_mov_b64 exec, -1
  v_lshlrev_b32 v72, 16, v64
  v_and_b32 v73, 0xffff0000, v64
  v_lshlrev_b32 v74, 16, v65
  v_and_b32 v75, 0xffff0000, v65
  v_lshlrev_b32 v76, 16, v66
  v_and_b32 v77, 0xffff0000, v66
  v_lshlrev_b32 v78, 16, v67
  v_and_b32 v79, 0xffff0000, v67
  v_lshlrev_b32 v80, 16, v68
  v_and_b32 v81, 0xffff0000, v68
  v_lshlrev_b32 v82, 16, v69
  v_and_b32 v83, 0xffff0000, v69
  v_lshlrev_b32 v84, 16, v70
  v_and_b32 v85, 0xffff0000, v70
  v_lshlrev_b32 v86, 16, v71
  v_and_b32 v87, 0xffff0000, v71
  v_add_f32 v44, v72, v73
  v_add_f32 v45, v74, v75
  v_add_f32 v44, v44, v76
  v_add_f32 v44, v44, v77
  v_add_f32 v45, v45, v78
  v_add_f32 v45, v45, v79
  v_add_f32 v44, v44, v80
  v_add_f32 v44, v44, v81
  v_add_f32 v45, v45, v82
  v_add_f32 v45, v45, v83
  v_add_f32 v44, v44, v84
  v_add_f32 v44, v44, v85
  v_add_f32 v45, v45, v86
  v_add_f32 v45, v45, v87
  v_add_f32 v44, v44, v45
  s_nop 1
  v_add_f32_dpp v44, v44, v44 row_ror:8 row_mask:0xf bank_mask:0xf
  s_nop 1
  v_add_f32_dpp v44, v44, v44 row_ror:4 row_mask:0xf bank_mask:0xf
  s_nop 1
  v_add_f32_dpp v44, v44, v44 row_ror:2 row_mask:0xf bank_mask:0xf
  s_nop 1
  v_add_f32_dpp v44, v44, v44 row_ror:1 row_mask:0xf bank_mask:0xf
  v_mov_b32 v45, v44
  s_nop 1
  v_permlane16_swap_b32 v44, v45
  s_nop 1
  v_add_f32 v44, v44, v45
  v_mul_f32 v44, 0x3b124925, v44
  v_mov_b32 v46, 0
  v_mov_b32 v47, 0
  v_cmp_gt_u32 vcc, 28, v39
  s_and_saveexec_b64 s[68:69], vcc
  v_sub_f32 v88, v72, v44
  v_fmac_f32 v46, v88, v88
  v_sub_f32 v89, v73, v44
  v_fmac_f32 v47, v89, v89
  v_sub_f32 v90, v74, v44
  v_fmac_f32 v46, v90, v90
  v_sub_f32 v91, v75, v44
  v_fmac_f32 v47, v91, v91
  v_sub_f32 v88, v76, v44
  v_fmac_f32 v46, v88, v88
  v_sub_f32 v89, v77, v44
  v_fmac_f32 v47, v89, v89
  v_sub_f32 v90, v78, v44
  v_fmac_f32 v46, v90, v90
  v_sub_f32 v91, v79, v44
  v_fmac_f32 v47, v91, v91
  v_sub_f32 v88, v80, v44
  v_fmac_f32 v46, v88, v88
  v_sub_f32 v89, v81, v44
  v_fmac_f32 v47, v89, v89
  v_sub_f32 v90, v82, v44
  v_fmac_f32 v46, v90, v90
  v_sub_f32 v91, v83, v44
  v_fmac_f32 v47, v91, v91
  v_sub_f32 v88, v84, v44
  v_fmac_f32 v46, v88, v88
  v_sub_f32 v89, v85, v44
  v_fmac_f32 v47, v89, v89
  v_sub_f32 v90, v86, v44
  v_fmac_f32 v46, v90, v90
  v_sub_f32 v91, v87, v44
  v_fmac_f32 v47, v91, v91
  s_mov_b64 exec, -1
  v_add_f32 v46, v46, v47
  s_nop 1
  v_add_f32_dpp v46, v46, v46 row_ror:8 row_mask:0xf bank_mask:0xf
  s_nop 1
  v_add_f32_dpp v46, v46, v46 row_ror:4 row_mask:0xf bank_mask:0xf
  s_nop 1
  v_add_f32_dpp v46, v46, v46 row_ror:2 row_mask:0xf bank_mask:0xf
  s_nop 1
  v_add_f32_dpp v46, v46, v46 row_ror:1 row_mask:0xf bank_mask:0xf
  v_mov_b32 v47, v46
  s_nop 1
  v_permlane16_swap_b32 v46, v47
  s_nop 1
  v_add_f32 v46, v46, v47
  v_mul_f32 v46, 0x3b124925, v46
  v_cvt_pk_bf16_f32 v44, v44, v46
  v_and_b32 v46, 0xffff0000, v44
  v_lshlrev_b32 v44, 16, v44
  v_add_f32 v46, 0x3727c5ac, v46
  v_cvt_pk_bf16_f32 v46, v46, v46
  v_and_b32 v46, 0xffff0000, v46
  v_sqrt_f32 v46, v46
  s_nop 0
  v_cvt_pk_bf16_f32 v46, v46, v46
  v_and_b32 v46, 0xffff0000, v46
  v_rcp_f32 v46, v46
  v_sub_f32 v72, v72, v44
  v_sub_f32 v73, v73, v44
  v_cvt_pk_bf16_f32 v64, v72, v73
  v_sub_f32 v74, v74, v44
  v_sub_f32 v75, v75, v44
  v_cvt_pk_bf16_f32 v65, v74, v75
  v_sub_f32 v76, v76, v44
  v_sub_f32 v77, v77, v44
  v_cvt_pk_bf16_f32 v66, v76, v77
  v_sub_f32 v78, v78, v44
  v_sub_f32 v79, v79, v44
  v_cvt_pk_bf16_f32 v67, v78, v79
  v_sub_f32 v80, v80, v44
  v_sub_f32 v81, v81, v44
  v_cvt_pk_bf16_f32 v68, v80, v81
  v_sub_f32 v82, v82, v44
  v_sub_f32 v83, v83, v44
  v_cvt_pk_bf16_f32 v69, v82, v83
  v_sub_f32 v84, v84, v44
  v_sub_f32 v85, v85, v44
  v_cvt_pk_bf16_f32 v70, v84, v85
  v_sub_f32 v86, v86, v44
  v_sub_f32 v87, v87, v44
  v_cvt_pk_bf16_f32 v71, v86, v87
  v_lshlrev_b32 v72, 16, v64
  v_and_b32 v73, 0xffff0000, v64
  v_mul_f32 v72, v72, v46
  v_mul_f32 v73, v73, v46
  v_cvt_pk_bf16_f32 v64, v72, v73
  v_lshlrev_b32 v74, 16, v65
  v_and_b32 v75, 0xffff0000, v65
  v_mul_f32 v74, v74, v46
  v_mul_f32 v75, v75, v46
  v_cvt_pk_bf16_f32 v65, v74, v75
  v_lshlrev_b32 v76, 16, v66
  v_and_b32 v77, 0xffff0000, v66
  v_mul_f32 v76, v76, v46
  v_mul_f32 v77, v77, v46
  v_cvt_pk_bf16_f32 v66, v76, v77
  v_lshlrev_b32 v78, 16, v67
  v_and_b32 v79, 0xffff0000, v67
  v_mul_f32 v78, v78, v46
  v_mul_f32 v79, v79, v46
  v_cvt_pk_bf16_f32 v67, v78, v79
  v_lshlrev_b32 v80, 16, v68
  v_and_b32 v81, 0xffff0000, v68
  v_mul_f32 v80, v80, v46
  v_mul_f32 v81, v81, v46
  v_cvt_pk_bf16_f32 v68, v80, v81
  v_lshlrev_b32 v82, 16, v69
  v_and_b32 v83, 0xffff0000, v69
  v_mul_f32 v82, v82, v46
  v_mul_f32 v83, v83, v46
  v_cvt_pk_bf16_f32 v69, v82, v83
  v_lshlrev_b32 v84, 16, v70
  v_and_b32 v85, 0xffff0000, v70
  v_mul_f32 v84, v84, v46
  v_mul_f32 v85, v85, v46
  v_cvt_pk_bf16_f32 v70, v84, v85
  v_lshlrev_b32 v86, 16, v71
  v_and_b32 v87, 0xffff0000, v71
  v_mul_f32 v86, v86, v46
  v_mul_f32 v87, v87, v46
  v_cvt_pk_bf16_f32 v71, v86, v87
  s_mul_i32 s68, s27, 7
  v_subrev_u32 v42, s68, v39
  v_mul_u32_u24 v41, 224, v40
  v_lshl_add_u32 v41, v42, 5, v41
  v_add_u32 v41, 159744, v41
  v_cmp_gt_u32 vcc, 7, v42
  s_and_saveexec_b64 s[68:69], vcc
  ds_write_b128 v41, v[64:67]
  ds_write_b128 v41, v[68:71] offset:16
  s_mov_b64 exec, -1
  s_add_u32 s69, s70, 0
  s_add_u32 m0, s72, 0
  s_nop 0
  buffer_load_dwordx4 v2, s[28:31], s69 offen offset:0 nt lds
  buffer_load_dwordx4 v3, s[28:31], s69 offen offset:1024 nt lds
  buffer_load_dwordx4 v4, s[28:31], s69 offen offset:2048 nt lds
  buffer_load_dwordx4 v5, s[28:31], s69 offen offset:3072 nt lds
  s_add_u32 m0, s72, 4096
  s_nop 0
  buffer_load_dwordx4 v6, s[28:31], s69 offen offset:0 nt lds
  buffer_load_dwordx4 v7, s[28:31], s69 offen offset:1024 nt lds
  buffer_load_dwordx4 v8, s[28:31], s69 offen offset:2048 nt lds
  buffer_load_dwordx4 v9, s[28:31], s69 offen offset:3072 nt lds
  v_lshlrev_b32 v44, 1, v38
  v_xor_b32 v44, v39, v44
  v_lshlrev_b32 v44, 4, v44
  v_lshl_or_b32 v44, v38, 9, v44
  v_mov_b32 v10, v44
  v_xor_b32 v11, 64, v44
  v_xor_b32 v12, 128, v44
  v_xor_b32 v13, 192, v44
  v_xor_b32 v14, 4096, v44
  v_xor_b32 v15, 4160, v44
  v_xor_b32 v16, 4224, v44
  v_xor_b32 v17, 4288, v44
  s_waitcnt vmcnt(8) lgkmcnt(0)
  s_barrier
  s_add_u32 s64, s65, 1
  s_and_b32 s64, s64, 0xff
  v_mov_b32 v63, s64
  v_and_b32 v37, 15, v1
  v_lshrrev_b32 v38, 4, v1
  v_lshrrev_b32 v44, 2, v1
  v_lshlrev_b32 v44, 7, v44
  v_bfe_u32 v45, v1, 3, 2
  v_xor_b32 v45, s3, v45
  v_lshl_add_u32 v44, v45, 5, v44
  v_and_b32 v45, 3, v1
  v_lshl_add_u32 v44, v45, 3, v44
  v_add_u32 v44, 131072, v44
  v_and_b32 v45, 7, v1
  v_mul_u32_u24 v45, 224, v45
  v_lshl_add_u32 v45, v38, 3, v45
  v_add_u32 v45, 159744, v45
  v_mov_b32 v194, v44
  v_mov_b32 v195, v45
  ds_read_b64_tr_b16 v[64:65], v44 offset:0
  ds_read_b64 v[80:81], v45 offset:0
  ds_read_b64_tr_b16 v[66:67], v44 offset:2048
  ds_read_b64 v[82:83], v45 offset:32
  ds_read_b64_tr_b16 v[68:69], v44 offset:4096
  ds_read_b64 v[84:85], v45 offset:64
  ds_read_b64_tr_b16 v[70:71], v44 offset:6144
  ds_read_b64 v[86:87], v45 offset:96
  ds_read_b64_tr_b16 v[72:73], v44 offset:8192
  ds_read_b64 v[88:89], v45 offset:128
  ds_read_b64_tr_b16 v[74:75], v44 offset:10240
  ds_read_b64 v[90:91], v45 offset:160
  ds_read_b64_tr_b16 v[76:77], v44 offset:12288
  ds_read_b64 v[92:93], v45 offset:192
  v_lshlrev_b32 v46, 13, v37
  v_lshl_add_u32 v46, v38, 4, v46
  s_lshl_b32 s68, s26, 16
  s_lshl_b32 s69, s27, 11
  s_add_u32 s68, s68, s69
  s_lshl_b32 s69, s10, 8
  s_add_u32 s68, s68, s69
  s_lshl_b32 s69, s3, 6
  s_add_u32 s68, s68, s69
  s_add_u32 s68, s68, 524288
  v_cmp_gt_u32 vcc, 8, v37
  s_mov_b64 s[98:99], vcc
  s_waitcnt lgkmcnt(0)
  v_mfma_f32_16x16x16_bf16 v[48:51], v[64:65], v[80:81], 0
  v_mfma_f32_16x16x16_bf16 v[48:51], v[66:67], v[82:83], v[48:51]
  v_mfma_f32_16x16x16_bf16 v[48:51], v[68:69], v[84:85], v[48:51]
  v_mfma_f32_16x16x16_bf16 v[48:51], v[70:71], v[86:87], v[48:51]
  v_mfma_f32_16x16x16_bf16 v[48:51], v[72:73], v[88:89], v[48:51]
  v_mfma_f32_16x16x16_bf16 v[48:51], v[74:75], v[90:91], v[48:51]
  v_mfma_f32_16x16x16_bf16 v[48:51], v[76:77], v[92:93], v[48:51]
  s_nop 7
  v_add_u32 v48, 0x80, v48
  v_add_u32 v49, 0x80, v49
  v_add_u32 v50, 0x80, v50
  v_add_u32 v51, 0x80, v51
  v_and_or_b32 v48, v48, s66, v63
  v_and_or_b32 v49, v49, s66, v63
  v_and_or_b32 v50, v50, s66, v63
  v_and_or_b32 v51, v51, s66, v63
  s_mov_b64 exec, s[98:99]
  buffer_store_dwordx4 v[48:51], v46, s[36:39], s68 offen sc1
  s_mov_b64 exec, -1
  s_add_u32 s69, s70, 65536
  s_add_u32 m0, s72, 8192
  s_nop 0
  buffer_load_dwordx4 v2, s[28:31], s69 offen offset:0 nt lds
  buffer_load_dwordx4 v3, s[28:31], s69 offen offset:1024 nt lds
  buffer_load_dwordx4 v4, s[28:31], s69 offen offset:2048 nt lds
  buffer_load_dwordx4 v5, s[28:31], s69 offen offset:3072 nt lds
  s_add_u32 m0, s72, 12288
  s_nop 0
  buffer_load_dwordx4 v6, s[28:31], s69 offen offset:0 nt lds
  buffer_load_dwordx4 v7, s[28:31], s69 offen offset:1024 nt lds
  buffer_load_dwordx4 v8, s[28:31], s69 offen offset:2048 nt lds
  buffer_load_dwordx4 v9, s[28:31], s69 offen offset:3072 nt lds
  v_and_b32 v44, 3, v37
  v_xor_b32 v44, v44, v38
  v_lshlrev_b32 v44, 4, v44
  v_lshl_or_b32 v44, v37, 9, v44
  v_add_u32 v44, s72, v44
  v_lshrrev_b32 v45, 2, v37
  v_lshlrev_b32 v45, 6, v45
  v_mov_b32 v46, v45
  v_add_u32 v25, v44, v46
  v_xor_b32 v46, 64, v45
  v_add_u32 v26, v44, v46
  v_xor_b32 v46, 128, v45
  v_add_u32 v27, v44, v46
  v_xor_b32 v46, 192, v45
  v_add_u32 v28, v44, v46
  v_lshrrev_b32 v44, 2, v1
  v_and_b32 v45, 7, v44
  v_lshlrev_b32 v45, 5, v45
  v_lshlrev_b32 v44, 9, v44
  v_and_b32 v46, 3, v1
  v_lshl_add_u32 v44, v46, 3, v44
  v_add_u32 v44, s72, v44
  v_mov_b32 v46, v45
  v_add_u32 v29, v44, v46
  v_xor_b32 v46, 32, v45
  v_add_u32 v30, v44, v46
  v_xor_b32 v46, 64, v45
  v_add_u32 v31, v44, v46
  v_xor_b32 v46, 96, v45
  v_add_u32 v32, v44, v46
  v_xor_b32 v46, 128, v45
  v_add_u32 v33, v44, v46
  v_xor_b32 v46, 160, v45
  v_add_u32 v34, v44, v46
  v_xor_b32 v46, 192, v45
  v_add_u32 v35, v44, v46
  v_xor_b32 v46, 224, v45
  v_add_u32 v36, v44, v46
  v_add_u32 v44, 0, v1
  v_mul_u32_u24 v45, 4682, v44
  v_lshrrev_b32 v45, 16, v45
  v_mul_u32_u24 v46, 14, v45
  v_sub_u32 v44, v44, v46
  v_mul_u32_u24 v45, 896, v45
  v_lshl_add_u32 v18, v44, 4, v45
  v_add_u32 v44, 64, v1
  v_mul_u32_u24 v45, 4682, v44
  v_lshrrev_b32 v45, 16, v45
  v_mul_u32_u24 v46, 14, v45
  v_sub_u32 v44, v44, v46
  v_mul_u32_u24 v45, 896, v45
  v_lshl_add_u32 v19, v44, 4, v45
  v_add_u32 v44, 128, v1
  v_mul_u32_u24 v45, 4682, v44
  v_lshrrev_b32 v45, 16, v45
  v_mul_u32_u24 v46, 14, v45
  v_sub_u32 v44, v44, v46
  v_mul_u32_u24 v45, 896, v45
  v_lshl_add_u32 v20, v44, 4, v45
  v_add_u32 v44, 192, v1
  v_mul_u32_u24 v45, 4682, v44
  v_lshrrev_b32 v45, 16, v45
  v_mul_u32_u24 v46, 14, v45
  v_sub_u32 v44, v44, v46
  v_mul_u32_u24 v45, 896, v45
  v_lshl_add_u32 v21, v44, 4, v45
  v_add_u32 v44, 256, v1
  v_mul_u32_u24 v45, 4682, v44
  v_lshrrev_b32 v45, 16, v45
  v_mul_u32_u24 v46, 14, v45
  v_sub_u32 v44, v44, v46
  v_mul_u32_u24 v45, 896, v45
  v_lshl_add_u32 v22, v44, 4, v45
  v_add_u32 v44, 320, v1
  v_mul_u32_u24 v45, 4682, v44
  v_lshrrev_b32 v45, 16, v45
  v_mul_u32_u24 v46, 14, v45
  v_sub_u32 v44, v44, v46
  v_mul_u32_u24 v45, 896, v45
  v_lshl_add_u32 v23, v44, 4, v45
  v_add_u32 v44, 384, v1
  v_mul_u32_u24 v45, 4682, v44
  v_lshrrev_b32 v45, 16, v45
  v_mul_u32_u24 v46, 14, v45
  v_sub_u32 v44, v44, v46
  v_mul_u32_u24 v45, 896, v45
  v_lshl_add_u32 v24, v44, 4, v45
  v_bfe_u32 v44, v1, 2, 2
  v_lshl_add_u32 v44, v38, 3, v44
  v_mul_u32_u24 v44, 224, v44
  v_and_b32 v45, 3, v1
  v_lshl_add_u32 v44, v45, 3, v44
  v_add_u32 v40, s72, v44
  s_mov_b32 s56, s14
  s_and_b32 s57, s15, 0xffff
  s_mov_b32 s58, 3670016
  s_mov_b32 s59, 0x20000
  s_lshl_b32 s68, s26, 9
  s_lshl_b32 s69, s27, 7
  s_add_u32 s68, s68, s69
  s_mul_i32 s73, s68, 896
  s_mul_i32 s69, s3, 224
  s_add_u32 s73, s73, s69
  s_mov_b32 s48, s20
  s_and_b32 s49, s21, 0xffff
  s_cmp_lt_u32 s2, 112
  s_cselect_b32 s50, 1605632, 0
  s_mov_b32 s51, 0x20000
  v_and_b32 v44, 7, v1
  v_lshlrev_b32 v44, 6, v44
  v_lshl_add_u32 v44, v38, 4, v44
  v_mov_b32 v45, 0x10000000
  s_cselect_b64 vcc, -1, 0
  v_cndmask_b32 v192, v45, v44, vcc
  s_cselect_b32 s98, s2, 0
  s_lshl_b32 s12, s98, 12
  s_add_u32 s12, s12, 2621440
  s_add_u32 s13, s12, 2048
  s_mul_i32 s14, s98, 14336
  s_mul_i32 s99, s3, 224
  s_add_u32 s14, s14, s99
  s_mul_i32 s15, s3, 3584
  s_add_u32 s15, s15, 131072
  s_cmp_eq_u32 s3, 3
  s_cbranch_scc1 L_q_poll
  s_waitcnt vmcnt(8)
  s_add_u32 s69, s70, 131072
  s_add_u32 m0, s72, 16384
  s_nop 0
  buffer_load_dwordx4 v2, s[28:31], s69 offen offset:0 nt lds
  buffer_load_dwordx4 v3, s[28:31], s69 offen offset:1024 nt lds
  buffer_load_dwordx4 v4, s[28:31], s69 offen offset:2048 nt lds
  buffer_load_dwordx4 v5, s[28:31], s69 offen offset:3072 nt lds
  s_add_u32 m0, s72, 20480
  s_nop 0
  buffer_load_dwordx4 v6, s[28:31], s69 offen offset:0 nt lds
  buffer_load_dwordx4 v7, s[28:31], s69 offen offset:1024 nt lds
  buffer_load_dwordx4 v8, s[28:31], s69 offen offset:2048 nt lds
  buffer_load_dwordx4 v9, s[28:31], s69 offen offset:3072 nt lds
  s_waitcnt vmcnt(8)
  s_add_u32 s69, s70, 196608
  s_add_u32 m0, s72, 24576
  s_nop 0
  buffer_load_dwordx4 v2, s[28:31], s69 offen offset:0 nt lds
  buffer_load_dwordx4 v3, s[28:31], s69 offen offset:1024 nt lds
  buffer_load_dwordx4 v4, s[28:31], s69 offen offset:2048 nt lds
  buffer_load_dwordx4 v5, s[28:31], s69 offen offset:3072 nt lds
  s_add_u32 m0, s72, 28672
  s_nop 0
  buffer_load_dwordx4 v6, s[28:31], s69 offen offset:0 nt lds
  buffer_load_dwordx4 v7, s[28:31], s69 offen offset:1024 nt lds
  buffer_load_dwordx4 v8, s[28:31], s69 offen offset:2048 nt lds
  buffer_load_dwordx4 v9, s[28:31], s69 offen offset:3072 nt lds
  s_branch L_q_wait
L_q_poll:
  s_lshl_b32 s68, s26, 16
  s_lshl_b32 s98, s10, 13
  s_add_u32 s68, s68, s98
  s_add_u32 s101, s68, 524288
  s_add_u32 s100, s68, 524288
  s_mov_b32 s68, s100
  s_add_u32 s67, s68, 4096
  v_lshlrev_b32 v44, 5, v1
  buffer_load_dwordx4 v[64:67], v44, s[36:39], s68 offen offset:0 sc1
  buffer_load_dwordx4 v[68:71], v44, s[36:39], s68 offen offset:16 sc1
  buffer_load_dwordx4 v[72:75], v44, s[36:39], s68 offen offset:2048 sc1
  buffer_load_dwordx4 v[76:79], v44, s[36:39], s68 offen offset:2064 sc1
  buffer_load_dwordx4 v[80:83], v44, s[36:39], s67 offen offset:0 sc1
  buffer_load_dwordx4 v[84:87], v44, s[36:39], s67 offen offset:16 sc1
  buffer_load_dwordx4 v[88:91], v44, s[36:39], s67 offen offset:2048 sc1
  buffer_load_dwordx4 v[92:95], v44, s[36:39], s67 offen offset:2064 sc1
  s_add_u32 s69, s70, 131072
  s_add_u32 m0, s72, 16384
  s_nop 0
  buffer_load_dwordx4 v2, s[28:31], s69 offen offset:0 nt lds
  buffer_load_dwordx4 v3, s[28:31], s69 offen offset:1024 nt lds
  buffer_load_dwordx4 v4, s[28:31], s69 offen offset:2048 nt lds
  buffer_load_dwordx4 v5, s[28:31], s69 offen offset:3072 nt lds
  s_add_u32 m0, s72, 20480
  s_nop 0
  buffer_load_dwordx4 v6, s[28:31], s69 offen offset:0 nt lds
  buffer_load_dwordx4 v7, s[28:31], s69 offen offset:1024 nt lds
  buffer_load_dwordx4 v8, s[28:31], s69 offen offset:2048 nt lds
  buffer_load_dwordx4 v9, s[28:31], s69 offen offset:3072 nt lds
  s_waitcnt vmcnt(8)
  v_xor_b32 v64, v64, v63
  v_xor_b32 v65, v65, v63
  v_xor_b32 v66, v66, v63
  v_xor_b32 v67, v67, v63
  v_xor_b32 v68, v68, v63
  v_xor_b32 v69, v69, v63
  v_xor_b32 v70, v70, v63
  v_xor_b32 v71, v71, v63
  v_xor_b32 v72, v72, v63
  v_xor_b32 v73, v73, v63
  v_xor_b32 v74, v74, v63
  v_xor_b32 v75, v75, v63
  v_xor_b32 v76, v76, v63
  v_xor_b32 v77, v77, v63
  v_xor_b32 v78, v78, v63
  v_xor_b32 v79, v79, v63
  v_xor_b32 v80, v80, v63
  v_xor_b32 v81, v81, v63
  v_xor_b32 v82, v82, v63
  v_xor_b32 v83, v83, v63
  v_xor_b32 v84, v84, v63
  v_xor_b32 v85, v85, v63
  v_xor_b32 v86, v86, v63
  v_xor_b32 v87, v87, v63
  v_xor_b32 v88, v88, v63
  v_xor_b32 v89, v89, v63
  v_xor_b32 v90, v90, v63
  v_xor_b32 v91, v91, v63
  v_xor_b32 v92, v92, v63
  v_xor_b32 v93, v93, v63
  v_xor_b32 v94, v94, v63
  v_xor_b32 v95, v95, v63
  v_or_b32 v45, v64, v65
  v_or3_b32 v45, v45, v66, v67
  v_or3_b32 v45, v45, v68, v69
  v_or3_b32 v45, v45, v70, v71
  v_or3_b32 v45, v45, v72, v73
  v_or3_b32 v45, v45, v74, v75
  v_or3_b32 v45, v45, v76, v77
  v_or3_b32 v45, v45, v78, v79
  v_or3_b32 v45, v45, v80, v81
  v_or3_b32 v45, v45, v82, v83
  v_or3_b32 v45, v45, v84, v85
  v_or3_b32 v45, v45, v86, v87
  v_or3_b32 v45, v45, v88, v89
  v_or3_b32 v45, v45, v90, v91
  v_or3_b32 v45, v45, v92, v93
  v_or3_b32 v45, v45, v94, v95
  v_and_b32 v45, 0xff, v45
  v_cmp_eq_u32 vcc, 0, v45
  s_nop 1
  s_cmp_eq_u64 vcc, -1
  s_cbranch_scc1 L_q_ok2
  s_mov_b32 s69, 200000
L_qp_1:
  buffer_load_dwordx4 v[64:67], v44, s[36:39], s68 offen offset:0 sc1
  buffer_load_dwordx4 v[68:71], v44, s[36:39], s68 offen offset:16 sc1
  buffer_load_dwordx4 v[72:75], v44, s[36:39], s68 offen offset:2048 sc1
  buffer_load_dwordx4 v[76:79], v44, s[36:39], s68 offen offset:2064 sc1
  buffer_load_dwordx4 v[80:83], v44, s[36:39], s67 offen offset:0 sc1
  buffer_load_dwordx4 v[84:87], v44, s[36:39], s67 offen offset:16 sc1
  buffer_load_dwordx4 v[88:91], v44, s[36:39], s67 offen offset:2048 sc1
  buffer_load_dwordx4 v[92:95], v44, s[36:39], s67 offen offset:2064 sc1
  s_waitcnt vmcnt(0)
  v_xor_b32 v64, v64, v63
  v_xor_b32 v65, v65, v63
  v_xor_b32 v66, v66, v63
  v_xor_b32 v67, v67, v63
  v_xor_b32 v68, v68, v63
  v_xor_b32 v69, v69, v63
  v_xor_b32 v70, v70, v63
  v_xor_b32 v71, v71, v63
  v_xor_b32 v72, v72, v63
  v_xor_b32 v73, v73, v63
  v_xor_b32 v74, v74, v63
  v_xor_b32 v75, v75, v63
  v_xor_b32 v76, v76, v63
  v_xor_b32 v77, v77, v63
  v_xor_b32 v78, v78, v63
  v_xor_b32 v79, v79, v63
  v_xor_b32 v80, v80, v63
  v_xor_b32 v81, v81, v63
  v_xor_b32 v82, v82, v63
  v_xor_b32 v83, v83, v63
  v_xor_b32 v84, v84, v63
  v_xor_b32 v85, v85, v63
  v_xor_b32 v86, v86, v63
  v_xor_b32 v87, v87, v63
  v_xor_b32 v88, v88, v63
  v_xor_b32 v89, v89, v63
  v_xor_b32 v90, v90, v63
  v_xor_b32 v91, v91, v63
  v_xor_b32 v92, v92, v63
  v_xor_b32 v93, v93, v63
  v_xor_b32 v94, v94, v63
  v_xor_b32 v95, v95, v63
  v_or_b32 v45, v64, v65
  v_or3_b32 v45, v45, v66, v67
  v_or3_b32 v45, v45, v68, v69
  v_or3_b32 v45, v45, v70, v71
  v_or3_b32 v45, v45, v72, v73
  v_or3_b32 v45, v45, v74, v75
  v_or3_b32 v45, v45, v76, v77
  v_or3_b32 v45, v45, v78, v79
  v_or3_b32 v45, v45, v80, v81
  v_or3_b32 v45, v45, v82, v83
  v_or3_b32 v45, v45, v84, v85
  v_or3_b32 v45, v45, v86, v87
  v_or3_b32 v45, v45, v88, v89
  v_or3_b32 v45, v45, v90, v91
  v_or3_b32 v45, v45, v92, v93
  v_or3_b32 v45, v45, v94, v95
  v_and_b32 v45, 0xff, v45
  v_cmp_eq_u32 vcc, 0, v45
  s_nop 1
  s_andn2_b64 exec, exec, vcc
  s_cbranch_scc0 L_qpok_2
  s_sub_u32 s69, s69, 1
  s_cmp_eq_u32 s69, 0
  s_cbranch_scc1 L_qpok_2
  s_branch L_qp_1
L_qpok_2:
  s_mov_b64 exec, -1
L_q_ok2:
  s_add_u32 s69, s70, 196608
  s_add_u32 m0, s72, 24576
  s_nop 0
  buffer_load_dwordx4 v2, s[28:31], s69 offen offset:0 nt lds
  buffer_load_dwordx4 v3, s[28:31], s69 offen offset:1024 nt lds
  buffer_load_dwordx4 v4, s[28:31], s69 offen offset:2048 nt lds
  buffer_load_dwordx4 v5, s[28:31], s69 offen offset:3072 nt lds
  s_add_u32 m0, s72, 28672
  s_nop 0
  buffer_load_dwordx4 v6, s[28:31], s69 offen offset:0 nt lds
  buffer_load_dwordx4 v7, s[28:31], s69 offen offset:1024 nt lds
  buffer_load_dwordx4 v8, s[28:31], s69 offen offset:2048 nt lds
  buffer_load_dwordx4 v9, s[28:31], s69 offen offset:3072 nt lds
L_q_ok3:
  v_add_f32 v64, v64, v72
  v_add_f32 v80, v80, v88
  v_add_f32 v65, v65, v73
  v_add_f32 v81, v81, v89
  v_add_f32 v66, v66, v74
  v_add_f32 v82, v82, v90
  v_add_f32 v67, v67, v75
  v_add_f32 v83, v83, v91
  v_add_f32 v68, v68, v76
  v_add_f32 v84, v84, v92
  v_add_f32 v69, v69, v77
  v_add_f32 v85, v85, v93
  v_add_f32 v70, v70, v78
  v_add_f32 v86, v86, v94
  v_add_f32 v71, v71, v79
  v_add_f32 v87, v87, v95
  v_add_f32 v64, v64, v80
  v_add_f32 v65, v65, v81
  v_add_f32 v66, v66, v82
  v_add_f32 v67, v67, v83
  v_add_f32 v68, v68, v84
  v_add_f32 v69, v69, v85
  v_add_f32 v70, v70, v86
  v_add_f32 v71, v71, v87
  v_cvt_pk_bf16_f32 v72, v64, v65
  v_cvt_pk_bf16_f32 v73, v66, v67
  v_cvt_pk_bf16_f32 v74, v68, v69
  v_cvt_pk_bf16_f32 v75, v70, v71
  v_lshlrev_b32 v44, 4, v1
  v_add_u32 v44, 161536, v44
  ds_write_b128 v44, v[72:75]
L_q_wait:
  s_waitcnt lgkmcnt(0)
  s_barrier
  v_and_b32 v44, 1, v1
  v_lshlrev_b32 v44, 9, v44
  v_lshl_add_u32 v44, v38, 4, v44
  v_add_u32 v44, 161536, v44
  ds_read_b128 v[96:99], v44 offset:0
  ds_read_b128 v[100:103], v44 offset:64
  ds_read_b128 v[104:107], v44 offset:128
  ds_read_b128 v[108:111], v44 offset:192
  ds_read_b128 v[112:115], v44 offset:256
  ds_read_b128 v[116:119], v44 offset:320
  ds_read_b128 v[120:123], v44 offset:384
  ds_read_b128 v[124:127], v44 offset:448
  v_mov_b32 v60, 0xff800000
  s_waitcnt vmcnt(24)
  ds_read_b128 v[64:67], v25 offset:0
  ds_read_b128 v[68:71], v26 offset:0
  ds_read_b128 v[72:75], v27 offset:0
  ds_read_b128 v[76:79], v28 offset:0
  ds_read_b128 v[80:83], v25 offset:256
  ds_read_b128 v[84:87], v26 offset:256
  ds_read_b128 v[88:91], v27 offset:256
  ds_read_b128 v[92:95], v28 offset:256
  s_waitcnt lgkmcnt(0)
  s_cmp_lt_u32 s75, 28
  s_cselect_b32 s44, s16, s18
  s_cselect_b32 s45, s17, s19
  s_cselect_b32 s97, 0, 28
  s_and_b32 s45, s45, 0xffff
  s_cmp_lt_u32 s75, 56
  s_cselect_b32 s46, 1605632, 0
  s_mov_b32 s47, 0x20000
  s_sub_u32 s97, s75, s97
  s_lshl_b32 s68, s97, 7
  s_mul_i32 s69, s27, 112
  s_lshl_b32 s67, s3, 3
  s_add_u32 s67, s67, s69
  s_mul_i32 s69, s67, 3584
  s_add_u32 s68, s68, s69
  s_lshl_b32 s98, s3, 10
  s_add_u32 s98, s98, 145408
  s_add_u32 m0, s98, 0
  s_mov_b32 s99, s68
  buffer_load_dwordx4 v197, s[44:47], s99 offen  lds
  s_add_u32 m0, s98, 4096
  s_add_u32 s99, s68, 114688
  buffer_load_dwordx4 v197, s[44:47], s99 offen  lds
  s_add_u32 m0, s98, 8192
  s_add_u32 s99, s68, 229376
  buffer_load_dwordx4 v197, s[44:47], s99 offen  lds
  s_lshl_b32 s69, s96, 10
  s_add_u32 m0, s98, s69
  s_mul_i32 s69, s96, 28672
  s_add_u32 s99, s68, s69
  buffer_load_dwordx4 v197, s[44:47], s99 offen  lds
  s_add_u32 m0, s72, 0
  s_nop 0
  buffer_load_dwordx4 v18, s[56:59], s73 offen  lds
  s_add_u32 m0, s72, 1024
  s_nop 0
  buffer_load_dwordx4 v19, s[56:59], s73 offen  lds
  s_add_u32 m0, s72, 2048
  s_nop 0
  buffer_load_dwordx4 v20, s[56:59], s73 offen  lds
  s_add_u32 m0, s72, 3072
  s_nop 0
  buffer_load_dwordx4 v21, s[56:59], s73 offen  lds
  s_add_u32 m0, s72, 4096
  s_nop 0
  buffer_load_dwordx4 v22, s[56:59], s73 offen  lds
  s_add_u32 m0, s72, 5120
  s_nop 0
  buffer_load_dwordx4 v23, s[56:59], s73 offen  lds
  s_add_u32 m0, s72, 6144
  s_nop 0
  buffer_load_dwordx4 v24, s[56:59], s73 offen  lds
  s_add_u32 s73, s73, 28672
  v_mfma_f32_16x16x32_bf16 v[44:47], v[64:67], v[96:99], 0
  v_mfma_f32_16x16x32_bf16 v[44:47], v[68:71], v[100:103], v[44:47]
  v_mfma_f32_16x16x32_bf16 v[44:47], v[72:75], v[104:107], v[44:47]
  v_mfma_f32_16x16x32_bf16 v[44:47], v[76:79], v[108:111], v[44:47]
  v_mfma_f32_16x16x32_bf16 v[44:47], v[80:83], v[112:115], v[44:47]
  v_mfma_f32_16x16x32_bf16 v[44:47], v[84:87], v[116:119], v[44:47]
  v_mfma_f32_16x16x32_bf16 v[44:47], v[88:91], v[120:123], v[44:47]
  v_mfma_f32_16x16x32_bf16 v[44:47], v[92:95], v[124:127], v[44:47]
  s_nop 7
  v_max3_f32 v60, v60, v44, v45
  v_cvt_pk_bf16_f32 v128, v44, v45
  v_max3_f32 v60, v60, v46, v47
  v_cvt_pk_bf16_f32 v129, v46, v47
  s_waitcnt vmcnt(27)
  ds_read_b128 v[64:67], v25 offset:8192
  ds_read_b128 v[68:71], v26 offset:8192
  ds_read_b128 v[72:75], v27 offset:8192
  ds_read_b128 v[76:79], v28 offset:8192
  ds_read_b128 v[80:83], v25 offset:8448
  ds_read_b128 v[84:87], v26 offset:8448
  ds_read_b128 v[88:91], v27 offset:8448
  ds_read_b128 v[92:95], v28 offset:8448
  s_waitcnt lgkmcnt(0)
  s_add_u32 s69, s70, 262144
  s_add_u32 m0, s72, 8192
  s_nop 0
  buffer_load_dwordx4 v2, s[28:31], s69 offen offset:0 nt lds
  buffer_load_dwordx4 v3, s[28:31], s69 offen offset:1024 nt lds
  buffer_load_dwordx4 v4, s[28:31], s69 offen offset:2048 nt lds
  buffer_load_dwordx4 v5, s[28:31], s69 offen offset:3072 nt lds
  s_add_u32 m0, s72, 12288
  s_nop 0
  buffer_load_dwordx4 v6, s[28:31], s69 offen offset:0 nt lds
  buffer_load_dwordx4 v7, s[28:31], s69 offen offset:1024 nt lds
  buffer_load_dwordx4 v8, s[28:31], s69 offen offset:2048 nt lds
  buffer_load_dwordx4 v9, s[28:31], s69 offen offset:3072 nt lds
  v_mfma_f32_16x16x32_bf16 v[48:51], v[64:67], v[96:99], 0
  v_mfma_f32_16x16x32_bf16 v[48:51], v[68:71], v[100:103], v[48:51]
  v_mfma_f32_16x16x32_bf16 v[48:51], v[72:75], v[104:107], v[48:51]
  v_mfma_f32_16x16x32_bf16 v[48:51], v[76:79], v[108:111], v[48:51]
  v_mfma_f32_16x16x32_bf16 v[48:51], v[80:83], v[112:115], v[48:51]
  v_mfma_f32_16x16x32_bf16 v[48:51], v[84:87], v[116:119], v[48:51]
  v_mfma_f32_16x16x32_bf16 v[48:51], v[88:91], v[120:123], v[48:51]
  v_mfma_f32_16x16x32_bf16 v[48:51], v[92:95], v[124:127], v[48:51]
  s_nop 7
  v_max3_f32 v60, v60, v48, v49
  v_cvt_pk_bf16_f32 v130, v48, v49
  v_max3_f32 v60, v60, v50, v51
  v_cvt_pk_bf16_f32 v131, v50, v51
  s_waitcnt vmcnt(27)
  ds_read_b128 v[64:67], v25 offset:16384
  ds_read_b128 v[68:71], v26 offset:16384
  ds_read_b128 v[72:75], v27 offset:16384
  ds_read_b128 v[76:79], v28 offset:16384
  ds_read_b128 v[80:83], v25 offset:16640
  ds_read_b128 v[84:87], v26 offset:16640
  ds_read_b128 v[88:91], v27 offset:16640
  ds_read_b128 v[92:95], v28 offset:16640
  s_waitcnt lgkmcnt(0)
  s_add_u32 s69, s70, 327680
  s_add_u32 m0, s72, 16384
  s_nop 0
  buffer_load_dwordx4 v2, s[28:31], s69 offen offset:0 nt lds
  buffer_load_dwordx4 v3, s[28:31], s69 offen offset:1024 nt lds
  buffer_load_dwordx4 v4, s[28:31], s69 offen offset:2048 nt lds
  buffer_load_dwordx4 v5, s[28:31], s69 offen offset:3072 nt lds
  s_add_u32 m0, s72, 20480
  s_nop 0
  buffer_load_dwordx4 v6, s[28:31], s69 offen offset:0 nt lds
  buffer_load_dwordx4 v7, s[28:31], s69 offen offset:1024 nt lds
  buffer_load_dwordx4 v8, s[28:31], s69 offen offset:2048 nt lds
  buffer_load_dwordx4 v9, s[28:31], s69 offen offset:3072 nt lds
  v_mfma_f32_16x16x32_bf16 v[44:47], v[64:67], v[96:99], 0
  v_mfma_f32_16x16x32_bf16 v[44:47], v[68:71], v[100:103], v[44:47]
  v_mfma_f32_16x16x32_bf16 v[44:47], v[72:75], v[104:107], v[44:47]
  v_mfma_f32_16x16x32_bf16 v[44:47], v[76:79], v[108:111], v[44:47]
  v_mfma_f32_16x16x32_bf16 v[44:47], v[80:83], v[112:115], v[44:47]
  v_mfma_f32_16x16x32_bf16 v[44:47], v[84:87], v[116:119], v[44:47]
  v_mfma_f32_16x16x32_bf16 v[44:47], v[88:91], v[120:123], v[44:47]
  v_mfma_f32_16x16x32_bf16 v[44:47], v[92:95], v[124:127], v[44:47]
  s_nop 7
  v_max3_f32 v60, v60, v44, v45
  v_cvt_pk_bf16_f32 v132, v44, v45
  v_max3_f32 v60, v60, v46, v47
  v_cvt_pk_bf16_f32 v133, v46, v47
  s_waitcnt vmcnt(27)
  ds_read_b128 v[64:67], v25 offset:24576
  ds_read_b128 v[68:71], v26 offset:24576
  ds_read_b128 v[72:75], v27 offset:24576
  ds_read_b128 v[76:79], v28 offset:24576
  ds_read_b128 v[80:83], v25 offset:24832
  ds_read_b128 v[84:87], v26 offset:24832
  ds_read_b128 v[88:91], v27 offset:24832
  ds_read_b128 v[92:95], v28 offset:24832
  s_waitcnt lgkmcnt(0)
  s_add_u32 s69, s70, 393216
  s_add_u32 m0, s72, 24576
  s_nop 0
  buffer_load_dwordx4 v2, s[28:31], s69 offen offset:0 nt lds
  buffer_load_dwordx4 v3, s[28:31], s69 offen offset:1024 nt lds
  buffer_load_dwordx4 v4, s[28:31], s69 offen offset:2048 nt lds
  buffer_load_dwordx4 v5, s[28:31], s69 offen offset:3072 nt lds
  s_add_u32 m0, s72, 28672
  s_nop 0
  buffer_load_dwordx4 v6, s[28:31], s69 offen offset:0 nt lds
  buffer_load_dwordx4 v7, s[28:31], s69 offen offset:1024 nt lds
  buffer_load_dwordx4 v8, s[28:31], s69 offen offset:2048 nt lds
  buffer_load_dwordx4 v9, s[28:31], s69 offen offset:3072 nt lds
  v_mfma_f32_16x16x32_bf16 v[48:51], v[64:67], v[96:99], 0
  v_mfma_f32_16x16x32_bf16 v[48:51], v[68:71], v[100:103], v[48:51]
  v_mfma_f32_16x16x32_bf16 v[48:51], v[72:75], v[104:107], v[48:51]
  v_mfma_f32_16x16x32_bf16 v[48:51], v[76:79], v[108:111], v[48:51]
  v_mfma_f32_16x16x32_bf16 v[48:51], v[80:83], v[112:115], v[48:51]
  v_mfma_f32_16x16x32_bf16 v[48:51], v[84:87], v[116:119], v[48:51]
  v_mfma_f32_16x16x32_bf16 v[48:51], v[88:91], v[120:123], v[48:51]
  v_mfma_f32_16x16x32_bf16 v[48:51], v[92:95], v[124:127], v[48:51]
  s_nop 7
  v_max3_f32 v60, v60, v48, v49
  v_cvt_pk_bf16_f32 v134, v48, v49
  v_max3_f32 v60, v60, v50, v51
  v_cvt_pk_bf16_f32 v135, v50, v51
  s_waitcnt vmcnt(24)
  ds_read_b64_tr_b16 a[64:65], v40 offset:0
  ds_read_b64_tr_b16 a[66:67], v40 offset:896
  ds_read_b64_tr_b16 a[80:81], v40 offset:32
  ds_read_b64_tr_b16 a[82:83], v40 offset:928
  ds_read_b64_tr_b16 a[96:97], v40 offset:64
  ds_read_b64_tr_b16 a[98:99], v40 offset:960
  ds_read_b64_tr_b16 a[112:113], v40 offset:96
  ds_read_b64_tr_b16 a[114:115], v40 offset:992
  ds_read_b64_tr_b16 a[128:129], v40 offset:128
  ds_read_b64_tr_b16 a[130:131], v40 offset:1024
  ds_read_b64_tr_b16 a[144:145], v40 offset:160
  ds_read_b64_tr_b16 a[146:147], v40 offset:1056
  ds_read_b64_tr_b16 a[160:161], v40 offset:192
  ds_read_b64_tr_b16 a[162:163], v40 offset:1088
  s_waitcnt lgkmcnt(0)
  s_add_u32 s69, s70, 458752
  s_add_u32 m0, s72, 0
  s_nop 0
  buffer_load_dwordx4 v2, s[28:31], s69 offen offset:0 nt lds
  buffer_load_dwordx4 v3, s[28:31], s69 offen offset:1024 nt lds
  buffer_load_dwordx4 v4, s[28:31], s69 offen offset:2048 nt lds
  buffer_load_dwordx4 v5, s[28:31], s69 offen offset:3072 nt lds
  s_add_u32 m0, s72, 4096
  s_nop 0
  buffer_load_dwordx4 v6, s[28:31], s69 offen offset:0 nt lds
  buffer_load_dwordx4 v7, s[28:31], s69 offen offset:1024 nt lds
  buffer_load_dwordx4 v8, s[28:31], s69 offen offset:2048 nt lds
  buffer_load_dwordx4 v9, s[28:31], s69 offen offset:3072 nt lds
  s_barrier
  s_cmp_lt_u32 s75, 56
  s_cbranch_scc0 L_f_done
  ds_read_b64_tr_b16 v[160:161], v194 offset:14336
  ds_read_b64 v[176:177], v195 offset:0
  ds_read_b64_tr_b16 v[162:163], v194 offset:16384
  ds_read_b64 v[178:179], v195 offset:32
  ds_read_b64_tr_b16 v[164:165], v194 offset:18432
  ds_read_b64 v[180:181], v195 offset:64
  ds_read_b64_tr_b16 v[166:167], v194 offset:20480
  ds_read_b64 v[182:183], v195 offset:96
  ds_read_b64_tr_b16 v[168:169], v194 offset:22528
  ds_read_b64 v[184:185], v195 offset:128
  ds_read_b64_tr_b16 v[170:171], v194 offset:24576
  ds_read_b64 v[186:187], v195 offset:160
  ds_read_b64_tr_b16 v[172:173], v194 offset:26624
  ds_read_b64 v[188:189], v195 offset:192
  v_lshlrev_b32 v196, 6, v37
  v_lshl_add_u32 v196, v38, 4, v196
  v_cmp_gt_u32 vcc, 8, v37
  s_mov_b64 s[98:99], vcc
  s_lshl_b32 s68, s97, 2
  s_add_u32 s68, s68, s3
  s_lshl_b32 s68, s68, 1
  s_cmp_lt_u32 s75, 28
  s_cselect_b32 s69, 0, 1
  s_add_u32 s68, s68, s69
  s_lshl_b32 s68, s68, 2
  s_add_u32 s68, s68, s27
  s_lshl_b32 s68, s68, 9
  s_add_u32 s68, s68, 2621440
  s_waitcnt lgkmcnt(0)
  v_mfma_f32_16x16x16_bf16 v[52:55], v[160:161], v[176:177], 0
  v_mfma_f32_16x16x16_bf16 v[52:55], v[162:163], v[178:179], v[52:55]
  v_mfma_f32_16x16x16_bf16 v[52:55], v[164:165], v[180:181], v[52:55]
  v_mfma_f32_16x16x16_bf16 v[52:55], v[166:167], v[182:183], v[52:55]
  v_mfma_f32_16x16x16_bf16 v[52:55], v[168:169], v[184:185], v[52:55]
  v_mfma_f32_16x16x16_bf16 v[52:55], v[170:171], v[186:187], v[52:55]
  v_mfma_f32_16x16x16_bf16 v[52:55], v[172:173], v[188:189], v[52:55]
  s_nop 7
  v_add_u32 v52, 0x80, v52
  v_add_u32 v53, 0x80, v53
  v_add_u32 v54, 0x80, v54
  v_add_u32 v55, 0x80, v55
  v_and_or_b32 v52, v52, s66, v63
  v_and_or_b32 v53, v53, s66, v63
  v_and_or_b32 v54, v54, s66, v63
  v_and_or_b32 v55, v55, s66, v63
  s_mov_b64 exec, s[98:99]
  buffer_store_dwordx4 v[52:55], v196, s[36:39], s68 offen sc1
  s_mov_b64 exec, -1
L_f_done:
  s_waitcnt vmcnt(24)
  ds_read_b128 v[64:67], v25 offset:8192
  ds_read_b128 v[68:71], v26 offset:8192
  ds_read_b128 v[72:75], v27 offset:8192
  ds_read_b128 v[76:79], v28 offset:8192
  ds_read_b128 v[80:83], v25 offset:8448
  ds_read_b128 v[84:87], v26 offset:8448
  ds_read_b128 v[88:91], v27 offset:8448
  ds_read_b128 v[92:95], v28 offset:8448
  s_waitcnt lgkmcnt(0)
  s_add_u32 m0, s72, 8192
  s_nop 0
  buffer_load_dwordx4 v18, s[56:59], s73 offen  lds
  s_add_u32 m0, s72, 9216
  s_nop 0
  buffer_load_dwordx4 v19, s[56:59], s73 offen  lds
  s_add_u32 m0, s72, 10240
  s_nop 0
  buffer_load_dwordx4 v20, s[56:59], s73 offen  lds
  s_add_u32 m0, s72, 11264
  s_nop 0
  buffer_load_dwordx4 v21, s[56:59], s73 offen  lds
  s_add_u32 m0, s72, 12288
  s_nop 0
  buffer_load_dwordx4 v22, s[56:59], s73 offen  lds
  s_add_u32 m0, s72, 13312
  s_nop 0
  buffer_load_dwordx4 v23, s[56:59], s73 offen  lds
  s_add_u32 m0, s72, 14336
  s_nop 0
  buffer_load_dwordx4 v24, s[56:59], s73 offen  lds
  s_add_u32 s73, s73, 28672
  v_mfma_f32_16x16x32_bf16 v[44:47], v[64:67], v[96:99], 0
  v_mfma_f32_16x16x32_bf16 v[44:47], v[68:71], v[100:103], v[44:47]
  v_mfma_f32_16x16x32_bf16 v[44:47], v[72:75], v[104:107], v[44:47]
  v_mfma_f32_16x16x32_bf16 v[44:47], v[76:79], v[108:111], v[44:47]
  v_mfma_f32_16x16x32_bf16 v[44:47], v[80:83], v[112:115], v[44:47]
  v_mfma_f32_16x16x32_bf16 v[44:47], v[84:87], v[116:119], v[44:47]
  v_mfma_f32_16x16x32_bf16 v[44:47], v[88:91], v[120:123], v[44:47]
  v_mfma_f32_16x16x32_bf16 v[44:47], v[92:95], v[124:127], v[44:47]
  s_nop 7
  v_max3_f32 v60, v60, v44, v45
  v_cvt_pk_bf16_f32 v136, v44, v45
  v_max3_f32 v60, v60, v46, v47
  v_cvt_pk_bf16_f32 v137, v46, v47
  s_waitcnt vmcnt(23)
  ds_read_b128 v[64:67], v25 offset:16384
  ds_read_b128 v[68:71], v26 offset:16384
  ds_read_b128 v[72:75], v27 offset:16384
  ds_read_b128 v[76:79], v28 offset:16384
  ds_read_b128 v[80:83], v25 offset:16640
  ds_read_b128 v[84:87], v26 offset:16640
  ds_read_b128 v[88:91], v27 offset:16640
  ds_read_b128 v[92:95], v28 offset:16640
  s_waitcnt lgkmcnt(0)
  s_add_u32 s69, s70, 524288
  s_add_u32 m0, s72, 16384
  s_nop 0
  buffer_load_dwordx4 v2, s[28:31], s69 offen offset:0 nt lds
  buffer_load_dwordx4 v3, s[28:31], s69 offen offset:1024 nt lds
  buffer_load_dwordx4 v4, s[28:31], s69 offen offset:2048 nt lds
  buffer_load_dwordx4 v5, s[28:31], s69 offen offset:3072 nt lds
  s_add_u32 m0, s72, 20480
  s_nop 0
  buffer_load_dwordx4 v6, s[28:31], s69 offen offset:0 nt lds
  buffer_load_dwordx4 v7, s[28:31], s69 offen offset:1024 nt lds
  buffer_load_dwordx4 v8, s[28:31], s69 offen offset:2048 nt lds
  buffer_load_dwordx4 v9, s[28:31], s69 offen offset:3072 nt lds
  v_mfma_f32_16x16x32_bf16 v[48:51], v[64:67], v[96:99], 0
  v_mfma_f32_16x16x32_bf16 v[48:51], v[68:71], v[100:103], v[48:51]
  v_mfma_f32_16x16x32_bf16 v[48:51], v[72:75], v[104:107], v[48:51]
  v_mfma_f32_16x16x32_bf16 v[48:51], v[76:79], v[108:111], v[48:51]
  v_mfma_f32_16x16x32_bf16 v[48:51], v[80:83], v[112:115], v[48:51]
  v_mfma_f32_16x16x32_bf16 v[48:51], v[84:87], v[116:119], v[48:51]
  v_mfma_f32_16x16x32_bf16 v[48:51], v[88:91], v[120:123], v[48:51]
  v_mfma_f32_16x16x32_bf16 v[48:51], v[92:95], v[124:127], v[48:51]
  s_nop 7
  v_max3_f32 v60, v60, v48, v49
  v_cvt_pk_bf16_f32 v138, v48, v49
  v_max3_f32 v60, v60, v50, v51
  v_cvt_pk_bf16_f32 v139, v50, v51
  s_waitcnt vmcnt(23)
  ds_read_b128 v[64:67], v25 offset:24576
  ds_read_b128 v[68:71], v26 offset:24576
  ds_read_b128 v[72:75], v27 offset:24576
  ds_read_b128 v[76:79], v28 offset:24576
  ds_read_b128 v[80:83], v25 offset:24832
  ds_read_b128 v[84:87], v26 offset:24832
  ds_read_b128 v[88:91], v27 offset:24832
  ds_read_b128 v[92:95], v28 offset:24832
  s_waitcnt lgkmcnt(0)
  s_add_u32 s69, s70, 589824
  s_add_u32 m0, s72, 24576
  s_nop 0
  buffer_load_dwordx4 v2, s[28:31], s69 offen offset:0 nt lds
  buffer_load_dwordx4 v3, s[28:31], s69 offen offset:1024 nt lds
  buffer_load_dwordx4 v4, s[28:31], s69 offen offset:2048 nt lds
  buffer_load_dwordx4 v5, s[28:31], s69 offen offset:3072 nt lds
  s_add_u32 m0, s72, 28672
  s_nop 0
  buffer_load_dwordx4 v6, s[28:31], s69 offen offset:0 nt lds
  buffer_load_dwordx4 v7, s[28:31], s69 offen offset:1024 nt lds
  buffer_load_dwordx4 v8, s[28:31], s69 offen offset:2048 nt lds
  buffer_load_dwordx4 v9, s[28:31], s69 offen offset:3072 nt lds
  v_mfma_f32_16x16x32_bf16 v[44:47], v[64:67], v[96:99], 0
  v_mfma_f32_16x16x32_bf16 v[44:47], v[68:71], v[100:103], v[44:47]
  v_mfma_f32_16x16x32_bf16 v[44:47], v[72:75], v[104:107], v[44:47]
  v_mfma_f32_16x16x32_bf16 v[44:47], v[76:79], v[108:111], v[44:47]
  v_mfma_f32_16x16x32_bf16 v[44:47], v[80:83], v[112:115], v[44:47]
  v_mfma_f32_16x16x32_bf16 v[44:47], v[84:87], v[116:119], v[44:47]
  v_mfma_f32_16x16x32_bf16 v[44:47], v[88:91], v[120:123], v[44:47]
  v_mfma_f32_16x16x32_bf16 v[44:47], v[92:95], v[124:127], v[44:47]
  s_nop 7
  v_max3_f32 v60, v60, v44, v45
  v_cvt_pk_bf16_f32 v140, v44, v45
  v_max3_f32 v60, v60, v46, v47
  v_cvt_pk_bf16_f32 v141, v46, v47
  s_waitcnt vmcnt(23)
  ds_read_b128 v[64:67], v25 offset:0
  ds_read_b128 v[68:71], v26 offset:0
  ds_read_b128 v[72:75], v27 offset:0
  ds_read_b128 v[76:79], v28 offset:0
  ds_read_b128 v[80:83], v25 offset:256
  ds_read_b128 v[84:87], v26 offset:256
  ds_read_b128 v[88:91], v27 offset:256
  ds_read_b128 v[92:95], v28 offset:256
  s_waitcnt lgkmcnt(0)
  s_add_u32 s69, s70, 655360
  s_add_u32 m0, s72, 0
  s_nop 0
  buffer_load_dwordx4 v2, s[28:31], s69 offen offset:0 nt lds
  buffer_load_dwordx4 v3, s[28:31], s69 offen offset:1024 nt lds
  buffer_load_dwordx4 v4, s[28:31], s69 offen offset:2048 nt lds
  buffer_load_dwordx4 v5, s[28:31], s69 offen offset:3072 nt lds
  s_add_u32 m0, s72, 4096
  s_nop 0
  buffer_load_dwordx4 v6, s[28:31], s69 offen offset:0 nt lds
  buffer_load_dwordx4 v7, s[28:31], s69 offen offset:1024 nt lds
  buffer_load_dwordx4 v8, s[28:31], s69 offen offset:2048 nt lds
  buffer_load_dwordx4 v9, s[28:31], s69 offen offset:3072 nt lds
  v_mfma_f32_16x16x32_bf16 v[48:51], v[64:67], v[96:99], 0
  v_mfma_f32_16x16x32_bf16 v[48:51], v[68:71], v[100:103], v[48:51]
  v_mfma_f32_16x16x32_bf16 v[48:51], v[72:75], v[104:107], v[48:51]
  v_mfma_f32_16x16x32_bf16 v[48:51], v[76:79], v[108:111], v[48:51]
  v_mfma_f32_16x16x32_bf16 v[48:51], v[80:83], v[112:115], v[48:51]
  v_mfma_f32_16x16x32_bf16 v[48:51], v[84:87], v[116:119], v[48:51]
  v_mfma_f32_16x16x32_bf16 v[48:51], v[88:91], v[120:123], v[48:51]
  v_mfma_f32_16x16x32_bf16 v[48:51], v[92:95], v[124:127], v[48:51]
  s_nop 7
  v_max3_f32 v60, v60, v48, v49
  v_cvt_pk_bf16_f32 v142, v48, v49
  v_max3_f32 v60, v60, v50, v51
  v_cvt_pk_bf16_f32 v143, v50, v51
  s_waitcnt vmcnt(24)
  ds_read_b64_tr_b16 a[68:69], v40 offset:8192
  ds_read_b64_tr_b16 a[70:71], v40 offset:9088
  ds_read_b64_tr_b16 a[84:85], v40 offset:8224
  ds_read_b64_tr_b16 a[86:87], v40 offset:9120
  ds_read_b64_tr_b16 a[100:101], v40 offset:8256
  ds_read_b64_tr_b16 a[102:103], v40 offset:9152
  ds_read_b64_tr_b16 a[116:117], v40 offset:8288
  ds_read_b64_tr_b16 a[118:119], v40 offset:9184
  ds_read_b64_tr_b16 a[132:133], v40 offset:8320
  ds_read_b64_tr_b16 a[134:135], v40 offset:9216
  ds_read_b64_tr_b16 a[148:149], v40 offset:8352
  ds_read_b64_tr_b16 a[150:151], v40 offset:9248
  ds_read_b64_tr_b16 a[164:165], v40 offset:8384
  ds_read_b64_tr_b16 a[166:167], v40 offset:9280
  s_waitcnt lgkmcnt(0)
  s_add_u32 s69, s70, 720896
  s_add_u32 m0, s72, 8192
  s_nop 0
  buffer_load_dwordx4 v2, s[28:31], s69 offen offset:0 nt lds
  buffer_load_dwordx4 v3, s[28:31], s69 offen offset:1024 nt lds
  buffer_load_dwordx4 v4, s[28:31], s69 offen offset:2048 nt lds
  buffer_load_dwordx4 v5, s[28:31], s69 offen offset:3072 nt lds
  s_add_u32 m0, s72, 12288
  s_nop 0
  buffer_load_dwordx4 v6, s[28:31], s69 offen offset:0 nt lds
  buffer_load_dwordx4 v7, s[28:31], s69 offen offset:1024 nt lds
  buffer_load_dwordx4 v8, s[28:31], s69 offen offset:2048 nt lds
  buffer_load_dwordx4 v9, s[28:31], s69 offen offset:3072 nt lds
  s_waitcnt vmcnt(24)
  ds_read_b128 v[64:67], v25 offset:16384
  ds_read_b128 v[68:71], v26 offset:16384
  ds_read_b128 v[72:75], v27 offset:16384
  ds_read_b128 v[76:79], v28 offset:16384
  ds_read_b128 v[80:83], v25 offset:16640
  ds_read_b128 v[84:87], v26 offset:16640
  ds_read_b128 v[88:91], v27 offset:16640
  ds_read_b128 v[92:95], v28 offset:16640
  s_waitcnt lgkmcnt(0)
  buffer_load_dwordx4 v[160:163], v192, s[36:39], s12 offen offset:0 sc1
  buffer_load_dwordx4 v[164:167], v192, s[36:39], s12 offen offset:512 sc1
  buffer_load_dwordx4 v[168:171], v192, s[36:39], s12 offen offset:1024 sc1
  buffer_load_dwordx4 v[172:175], v192, s[36:39], s12 offen offset:1536 sc1
  buffer_load_dwordx4 v[176:179], v192, s[36:39], s13 offen offset:0 sc1
  buffer_load_dwordx4 v[180:183], v192, s[36:39], s13 offen offset:512 sc1
  buffer_load_dwordx4 v[184:187], v192, s[36:39], s13 offen offset:1024 sc1
  buffer_load_dwordx4 v[188:191], v192, s[36:39], s13 offen offset:1536 sc1
  s_add_u32 m0, s15, 0
  s_nop 0
  buffer_load_dwordx4 v18, s[48:51], s14 offen  lds
  s_add_u32 m0, s15, 1024
  s_nop 0
  buffer_load_dwordx4 v19, s[48:51], s14 offen  lds
  s_add_u32 m0, s15, 2048
  s_nop 0
  buffer_load_dwordx4 v20, s[48:51], s14 offen  lds
  s_add_u32 m0, s15, 3072
  s_mov_b32 exec_hi, 0
  buffer_load_dwordx4 v21, s[48:51], s14 offen  lds
  s_mov_b64 exec, -1
  s_add_u32 m0, s72, 16384
  s_nop 0
  buffer_load_dwordx4 v18, s[56:59], s73 offen  lds
  s_add_u32 m0, s72, 17408
  s_nop 0
  buffer_load_dwordx4 v19, s[56:59], s73 offen  lds
  s_add_u32 m0, s72, 18432
  s_nop 0
  buffer_load_dwordx4 v20, s[56:59], s73 offen  lds
  s_add_u32 m0, s72, 19456
  s_nop 0
  buffer_load_dwordx4 v21, s[56:59], s73 offen  lds
  s_add_u32 m0, s72, 20480
  s_nop 0
  buffer_load_dwordx4 v22, s[56:59], s73 offen  lds
  s_add_u32 m0, s72, 21504
  s_nop 0
  buffer_load_dwordx4 v23, s[56:59], s73 offen  lds
  s_add_u32 m0, s72, 22528
  s_nop 0
  buffer_load_dwordx4 v24, s[56:59], s73 offen  lds
  s_add_u32 s73, s73, 28672
  v_mfma_f32_16x16x32_bf16 v[44:47], v[64:67], v[96:99], 0
  v_mfma_f32_16x16x32_bf16 v[44:47], v[68:71], v[100:103], v[44:47]
  v_mfma_f32_16x16x32_bf16 v[44:47], v[72:75], v[104:107], v[44:47]
  v_mfma_f32_16x16x32_bf16 v[44:47], v[76:79], v[108:111], v[44:47]
  v_mfma_f32_16x16x32_bf16 v[44:47], v[80:83], v[112:115], v[44:47]
  v_mfma_f32_16x16x32_bf16 v[44:47], v[84:87], v[116:119], v[44:47]
  v_mfma_f32_16x16x32_bf16 v[44:47], v[88:91], v[120:123], v[44:47]
  v_mfma_f32_16x16x32_bf16 v[44:47], v[92:95], v[124:127], v[44:47]
  s_nop 7
  v_max3_f32 v60, v60, v44, v45
  v_cvt_pk_bf16_f32 v144, v44, v45
  v_max3_f32 v60, v60, v46, v47
  v_cvt_pk_bf16_f32 v145, v46, v47
  s_waitcnt vmcnt(35)
  ds_read_b128 v[64:67], v25 offset:24576
  ds_read_b128 v[68:71], v26 offset:24576
  ds_read_b128 v[72:75], v27 offset:24576
  ds_read_b128 v[76:79], v28 offset:24576
  ds_read_b128 v[80:83], v25 offset:24832
  ds_read_b128 v[84:87], v26 offset:24832
  ds_read_b128 v[88:91], v27 offset:24832
  ds_read_b128 v[92:95], v28 offset:24832
  s_waitcnt lgkmcnt(0)
  s_add_u32 s69, s70, 786432
  s_add_u32 m0, s72, 24576
  s_nop 0
  buffer_load_dwordx4 v2, s[28:31], s69 offen offset:0 nt lds
  buffer_load_dwordx4 v3, s[28:31], s69 offen offset:1024 nt lds
  buffer_load_dwordx4 v4, s[28:31], s69 offen offset:2048 nt lds
  buffer_load_dwordx4 v5, s[28:31], s69 offen offset:3072 nt lds
  s_add_u32 m0, s72, 28672
  s_nop 0
  buffer_load_dwordx4 v6, s[28:31], s69 offen offset:0 nt lds
  buffer_load_dwordx4 v7, s[28:31], s69 offen offset:1024 nt lds
  buffer_load_dwordx4 v8, s[28:31], s69 offen offset:2048 nt lds
  buffer_load_dwordx4 v9, s[28:31], s69 offen offset:3072 nt lds
  v_mfma_f32_16x16x32_bf16 v[48:51], v[64:67], v[96:99], 0
  v_mfma_f32_16x16x32_bf16 v[48:51], v[68:71], v[100:103], v[48:51]
  v_mfma_f32_16x16x32_bf16 v[48:51], v[72:75], v[104:107], v[48:51]
  v_mfma_f32_16x16x32_bf16 v[48:51], v[76:79], v[108:111], v[48:51]
  v_mfma_f32_16x16x32_bf16 v[48:51], v[80:83], v[112:115], v[48:51]
  v_mfma_f32_16x16x32_bf16 v[48:51], v[84:87], v[116:119], v[48:51]
  v_mfma_f32_16x16x32_bf16 v[48:51], v[88:91], v[120:123], v[48:51]
  v_mfma_f32_16x16x32_bf16 v[48:51], v[92:95], v[124:127], v[48:51]
  s_nop 7
  v_max3_f32 v60, v60, v48, v49
  v_cvt_pk_bf16_f32 v146, v48, v49
  v_max3_f32 v60, v60, v50, v51
  v_cvt_pk_bf16_f32 v147, v50, v51
  s_waitcnt vmcnt(35)
  ds_read_b128 v[64:67], v25 offset:0
  ds_read_b128 v[68:71], v26 offset:0
  ds_read_b128 v[72:75], v27 offset:0
  ds_read_b128 v[76:79], v28 offset:0
  ds_read_b128 v[80:83], v25 offset:256
  ds_read_b128 v[84:87], v26 offset:256
  ds_read_b128 v[88:91], v27 offset:256
  ds_read_b128 v[92:95], v28 offset:256
  s_waitcnt lgkmcnt(0)
  s_add_u32 s69, s70, 851968
  s_add_u32 m0, s72, 0
  s_nop 0
  buffer_load_dwordx4 v2, s[28:31], s69 offen offset:0 nt lds
  buffer_load_dwordx4 v3, s[28:31], s69 offen offset:1024 nt lds
  buffer_load_dwordx4 v4, s[28:31], s69 offen offset:2048 nt lds
  buffer_load_dwordx4 v5, s[28:31], s69 offen offset:3072 nt lds
  s_add_u32 m0, s72, 4096
  s_nop 0
  buffer_load_dwordx4 v6, s[28:31], s69 offen offset:0 nt lds
  buffer_load_dwordx4 v7, s[28:31], s69 offen offset:1024 nt lds
  buffer_load_dwordx4 v8, s[28:31], s69 offen offset:2048 nt lds
  buffer_load_dwordx4 v9, s[28:31], s69 offen offset:3072 nt lds
  v_mfma_f32_16x16x32_bf16 v[44:47], v[64:67], v[96:99], 0
  v_mfma_f32_16x16x32_bf16 v[44:47], v[68:71], v[100:103], v[44:47]
  v_mfma_f32_16x16x32_bf16 v[44:47], v[72:75], v[104:107], v[44:47]
  v_mfma_f32_16x16x32_bf16 v[44:47], v[76:79], v[108:111], v[44:47]
  v_mfma_f32_16x16x32_bf16 v[44:47], v[80:83], v[112:115], v[44:47]
  v_mfma_f32_16x16x32_bf16 v[44:47], v[84:87], v[116:119], v[44:47]
  v_mfma_f32_16x16x32_bf16 v[44:47], v[88:91], v[120:123], v[44:47]
  v_mfma_f32_16x16x32_bf16 v[44:47], v[92:95], v[124:127], v[44:47]
  s_nop 7
  v_max3_f32 v60, v60, v44, v45
  v_cvt_pk_bf16_f32 v148, v44, v45
  v_max3_f32 v60, v60, v46, v47
  v_cvt_pk_bf16_f32 v149, v46, v47
  s_waitcnt vmcnt(35)
  ds_read_b128 v[64:67], v25 offset:8192
  ds_read_b128 v[68:71], v26 offset:8192
  ds_read_b128 v[72:75], v27 offset:8192
  ds_read_b128 v[76:79], v28 offset:8192
  ds_read_b128 v[80:83], v25 offset:8448
  ds_read_b128 v[84:87], v26 offset:8448
  ds_read_b128 v[88:91], v27 offset:8448
  ds_read_b128 v[92:95], v28 offset:8448
  s_waitcnt lgkmcnt(0)
  s_add_u32 s69, s70, 917504
  s_add_u32 m0, s72, 8192
  s_nop 0
  buffer_load_dwordx4 v2, s[28:31], s69 offen offset:0 nt lds
  buffer_load_dwordx4 v3, s[28:31], s69 offen offset:1024 nt lds
  buffer_load_dwordx4 v4, s[28:31], s69 offen offset:2048 nt lds
  buffer_load_dwordx4 v5, s[28:31], s69 offen offset:3072 nt lds
  s_add_u32 m0, s72, 12288
  s_nop 0
  buffer_load_dwordx4 v6, s[28:31], s69 offen offset:0 nt lds
  buffer_load_dwordx4 v7, s[28:31], s69 offen offset:1024 nt lds
  buffer_load_dwordx4 v8, s[28:31], s69 offen offset:2048 nt lds
  buffer_load_dwordx4 v9, s[28:31], s69 offen offset:3072 nt lds
  v_mfma_f32_16x16x32_bf16 v[48:51], v[64:67], v[96:99], 0
  v_mfma_f32_16x16x32_bf16 v[48:51], v[68:71], v[100:103], v[48:51]
  v_mfma_f32_16x16x32_bf16 v[48:51], v[72:75], v[104:107], v[48:51]
  v_mfma_f32_16x16x32_bf16 v[48:51], v[76:79], v[108:111], v[48:51]
  v_mfma_f32_16x16x32_bf16 v[48:51], v[80:83], v[112:115], v[48:51]
  v_mfma_f32_16x16x32_bf16 v[48:51], v[84:87], v[116:119], v[48:51]
  v_mfma_f32_16x16x32_bf16 v[48:51], v[88:91], v[120:123], v[48:51]
  v_mfma_f32_16x16x32_bf16 v[48:51], v[92:95], v[124:127], v[48:51]
  s_nop 7
  v_max3_f32 v60, v60, v48, v49
  v_cvt_pk_bf16_f32 v150, v48, v49
  v_max3_f32 v60, v60, v50, v51
  v_cvt_pk_bf16_f32 v151, v50, v51
  s_waitcnt vmcnt(24)
  ds_read_b64_tr_b16 a[72:73], v40 offset:16384
  ds_read_b64_tr_b16 a[74:75], v40 offset:17280
  ds_read_b64_tr_b16 a[88:89], v40 offset:16416
  ds_read_b64_tr_b16 a[90:91], v40 offset:17312
  ds_read_b64_tr_b16 a[104:105], v40 offset:16448
  ds_read_b64_tr_b16 a[106:107], v40 offset:17344
  ds_read_b64_tr_b16 a[120:121], v40 offset:16480
  ds_read_b64_tr_b16 a[122:123], v40 offset:17376
  ds_read_b64_tr_b16 a[136:137], v40 offset:16512
  ds_read_b64_tr_b16 a[138:139], v40 offset:17408
  ds_read_b64_tr_b16 a[152:153], v40 offset:16544
  ds_read_b64_tr_b16 a[154:155], v40 offset:17440
  ds_read_b64_tr_b16 a[168:169], v40 offset:16576
  ds_read_b64_tr_b16 a[170:171], v40 offset:17472
  s_waitcnt lgkmcnt(0)
  s_add_u32 s69, s70, 983040
  s_add_u32 m0, s72, 16384
  s_nop 0
  buffer_load_dwordx4 v2, s[28:31], s69 offen offset:0 nt lds
  buffer_load_dwordx4 v3, s[28:31], s69 offen offset:1024 nt lds
  buffer_load_dwordx4 v4, s[28:31], s69 offen offset:2048 nt lds
  buffer_load_dwordx4 v5, s[28:31], s69 offen offset:3072 nt lds
  s_add_u32 m0, s72, 20480
  s_nop 0
  buffer_load_dwordx4 v6, s[28:31], s69 offen offset:0 nt lds
  buffer_load_dwordx4 v7, s[28:31], s69 offen offset:1024 nt lds
  buffer_load_dwordx4 v8, s[28:31], s69 offen offset:2048 nt lds
  buffer_load_dwordx4 v9, s[28:31], s69 offen offset:3072 nt lds
  s_cmp_lt_u32 s2, 112
  s_cbranch_scc0 L_st2_done
  v_xor_b32 v160, v160, v63
  v_xor_b32 v161, v161, v63
  v_xor_b32 v162, v162, v63
  v_xor_b32 v163, v163, v63
  v_xor_b32 v164, v164, v63
  v_xor_b32 v165, v165, v63
  v_xor_b32 v166, v166, v63
  v_xor_b32 v167, v167, v63
  v_xor_b32 v168, v168, v63
  v_xor_b32 v169, v169, v63
  v_xor_b32 v170, v170, v63
  v_xor_b32 v171, v171, v63
  v_xor_b32 v172, v172, v63
  v_xor_b32 v173, v173, v63
  v_xor_b32 v174, v174, v63
  v_xor_b32 v175, v175, v63
  v_xor_b32 v176, v176, v63
  v_xor_b32 v177, v177, v63
  v_xor_b32 v178, v178, v63
  v_xor_b32 v179, v179, v63
  v_xor_b32 v180, v180, v63
  v_xor_b32 v181, v181, v63
  v_xor_b32 v182, v182, v63
  v_xor_b32 v183, v183, v63
  v_xor_b32 v184, v184, v63
  v_xor_b32 v185, v185, v63
  v_xor_b32 v186, v186, v63
  v_xor_b32 v187, v187, v63
  v_xor_b32 v188, v188, v63
  v_xor_b32 v189, v189, v63
  v_xor_b32 v190, v190, v63
  v_xor_b32 v191, v191, v63
  v_or_b32 v48, v160, v161
  v_or3_b32 v48, v48, v162, v163
  v_or3_b32 v48, v48, v164, v165
  v_or3_b32 v48, v48, v166, v167
  v_or3_b32 v48, v48, v168, v169
  v_or3_b32 v48, v48, v170, v171
  v_or3_b32 v48, v48, v172, v173
  v_or3_b32 v48, v48, v174, v175
  v_or3_b32 v48, v48, v176, v177
  v_or3_b32 v48, v48, v178, v179
  v_or3_b32 v48, v48, v180, v181
  v_or3_b32 v48, v48, v182, v183
  v_or3_b32 v48, v48, v184, v185
  v_or3_b32 v48, v48, v186, v187
  v_or3_b32 v48, v48, v188, v189
  v_or3_b32 v48, v48, v190, v191
  v_and_b32 v48, 0xff, v48
  v_cmp_eq_u32 vcc, 0, v48
  s_nop 1
  s_cmp_eq_u64 vcc, -1
  s_cbranch_scc1 L_st2_ok
  s_mov_b32 s69, 200000
L_fp_3:
  buffer_load_dwordx4 v[160:163], v192, s[36:39], s12 offen offset:0 sc1
  buffer_load_dwordx4 v[164:167], v192, s[36:39], s12 offen offset:512 sc1
  buffer_load_dwordx4 v[168:171], v192, s[36:39], s12 offen offset:1024 sc1
  buffer_load_dwordx4 v[172:175], v192, s[36:39], s12 offen offset:1536 sc1
  buffer_load_dwordx4 v[176:179], v192, s[36:39], s13 offen offset:0 sc1
  buffer_load_dwordx4 v[180:183], v192, s[36:39], s13 offen offset:512 sc1
  buffer_load_dwordx4 v[184:187], v192, s[36:39], s13 offen offset:1024 sc1
  buffer_load_dwordx4 v[188:191], v192, s[36:39], s13 offen offset:1536 sc1
  s_waitcnt vmcnt(0)
  v_xor_b32 v160, v160, v63
  v_xor_b32 v161, v161, v63
  v_xor_b32 v162, v162, v63
  v_xor_b32 v163, v163, v63
  v_xor_b32 v164, v164, v63
  v_xor_b32 v165, v165, v63
  v_xor_b32 v166, v166, v63
  v_xor_b32 v167, v167, v63
  v_xor_b32 v168, v168, v63
  v_xor_b32 v169, v169, v63
  v_xor_b32 v170, v170, v63
  v_xor_b32 v171, v171, v63
  v_xor_b32 v172, v172, v63
  v_xor_b32 v173, v173, v63
  v_xor_b32 v174, v174, v63
  v_xor_b32 v175, v175, v63
  v_xor_b32 v176, v176, v63
  v_xor_b32 v177, v177, v63
  v_xor_b32 v178, v178, v63
  v_xor_b32 v179, v179, v63
  v_xor_b32 v180, v180, v63
  v_xor_b32 v181, v181, v63
  v_xor_b32 v182, v182, v63
  v_xor_b32 v183, v183, v63
  v_xor_b32 v184, v184, v63
  v_xor_b32 v185, v185, v63
  v_xor_b32 v186, v186, v63
  v_xor_b32 v187, v187, v63
  v_xor_b32 v188, v188, v63
  v_xor_b32 v189, v189, v63
  v_xor_b32 v190, v190, v63
  v_xor_b32 v191, v191, v63
  v_or_b32 v48, v160, v161
  v_or3_b32 v48, v48, v162, v163
  v_or3_b32 v48, v48, v164, v165
  v_or3_b32 v48, v48, v166, v167
  v_or3_b32 v48, v48, v168, v169
  v_or3_b32 v48, v48, v170, v171
  v_or3_b32 v48, v48, v172, v173
  v_or3_b32 v48, v48, v174, v175
  v_or3_b32 v48, v48, v176, v177
  v_or3_b32 v48, v48, v178, v179
  v_or3_b32 v48, v48, v180, v181
  v_or3_b32 v48, v48, v182, v183
  v_or3_b32 v48, v48, v184, v185
  v_or3_b32 v48, v48, v186, v187
  v_or3_b32 v48, v48, v188, v189
  v_or3_b32 v48, v48, v190, v191
  v_and_b32 v48, 0xff, v48
  v_cmp_eq_u32 vcc, 0, v48
  s_nop 1
  s_andn2_b64 exec, exec, vcc
  s_cbranch_scc0 L_fpok_4
  s_sub_u32 s69, s69, 1
  s_cmp_eq_u32 s69, 0
  s_cbranch_scc1 L_fpok_4
  s_branch L_fp_3
L_fpok_4:
  s_mov_b64 exec, -1
L_st2_ok:
  v_lshrrev_b32 v200, 2, v1
  v_mul_u32_u24 v200, 224, v200
  v_and_b32 v201, 3, v1
  v_lshl_add_u32 v200, v201, 3, v200
  v_add_u32 v200, s15, v200
  ds_read_b64_tr_b16 v[208:209], v200 offset:0
  ds_read_b64_tr_b16 v[210:211], v200 offset:32
  ds_read_b64_tr_b16 v[212:213], v200 offset:64
  ds_read_b64_tr_b16 v[214:215], v200 offset:96
  ds_read_b64_tr_b16 v[216:217], v200 offset:128
  ds_read_b64_tr_b16 v[218:219], v200 offset:160
  ds_read_b64_tr_b16 v[220:221], v200 offset:192
  v_add_f32 v160, v160, v164
  v_add_f32 v168, v168, v172
  v_add_f32 v176, v176, v180
  v_add_f32 v184, v184, v188
  v_add_f32 v161, v161, v165
  v_add_f32 v169, v169, v173
  v_add_f32 v177, v177, v181
  v_add_f32 v185, v185, v189
  v_add_f32 v162, v162, v166
  v_add_f32 v170, v170, v174
  v_add_f32 v178, v178, v182
  v_add_f32 v186, v186, v190
  v_add_f32 v163, v163, v167
  v_add_f32 v171, v171, v175
  v_add_f32 v179, v179, v183
  v_add_f32 v187, v187, v191
  v_add_f32 v160, v160, v168
  v_add_f32 v176, v176, v184
  v_add_f32 v161, v161, v169
  v_add_f32 v177, v177, v185
  v_add_f32 v162, v162, v170
  v_add_f32 v178, v178, v186
  v_add_f32 v163, v163, v171
  v_add_f32 v179, v179, v187
  v_cvt_pk_bf16_f32 v164, v160, v161
  v_cvt_pk_bf16_f32 v165, v162, v163
  v_cvt_pk_bf16_f32 v166, v176, v177
  v_cvt_pk_bf16_f32 v167, v178, v179
  v_lshlrev_b32 v160, 16, v164
  v_and_b32 v161, 0xffff0000, v164
  v_lshlrev_b32 v162, 16, v165
  v_and_b32 v163, 0xffff0000, v165
  v_mul_f32 v168, 0xbfb8aa3b, v160
  v_mul_f32 v169, 0xbfb8aa3b, v161
  v_mul_f32 v170, 0xbfb8aa3b, v162
  v_mul_f32 v171, 0xbfb8aa3b, v163
  v_exp_f32 v168, v168
  v_exp_f32 v169, v169
  v_exp_f32 v170, v170
  v_exp_f32 v171, v171
  s_nop 0
  v_add_f32 v168, 1.0, v168
  v_add_f32 v169, 1.0, v169
  v_add_f32 v170, 1.0, v170
  v_add_f32 v171, 1.0, v171
  v_rcp_f32 v168, v168
  v_rcp_f32 v169, v169
  v_rcp_f32 v170, v170
  v_rcp_f32 v171, v171
  s_nop 0
  v_mul_f32 v160, v160, v168
  v_mul_f32 v161, v161, v169
  v_mul_f32 v162, v162, v170
  v_mul_f32 v163, v163, v171
  v_cvt_pk_bf16_f32 v164, v160, v161
  v_cvt_pk_bf16_f32 v165, v162, v163
  v_lshlrev_b32 v160, 16, v164
  v_and_b32 v161, 0xffff0000, v164
  v_lshlrev_b32 v162, 16, v165
  v_and_b32 v163, 0xffff0000, v165
  v_lshlrev_b32 v168, 16, v166
  v_and_b32 v169, 0xffff0000, v166
  v_lshlrev_b32 v170, 16, v167
  v_and_b32 v171, 0xffff0000, v167
  v_mul_f32 v160, v160, v168
  v_mul_f32 v161, v161, v169
  v_mul_f32 v162, v162, v170
  v_mul_f32 v163, v163, v171
  v_cvt_pk_bf16_f32 v164, v160, v161
  v_cvt_pk_bf16_f32 v165, v162, v163
  v_mul_u32_u24 v201, 1792, v37
  v_lshl_add_u32 v201, v38, 4, v201
  s_mul_i32 s68, s2, 14336
  s_mul_i32 s69, s3, 448
  s_add_u32 s68, s68, s69
  s_add_u32 s68, s68, 3145728
  v_cmp_gt_u32 vcc, 8, v37
  s_mov_b64 s[98:99], vcc
  s_waitcnt lgkmcnt(0)
  v_mfma_f32_16x16x16_bf16 v[224:227], v[208:209], v[164:165], 0
  v_mfma_f32_16x16x16_bf16 v[228:231], v[210:211], v[164:165], 0
  v_mfma_f32_16x16x16_bf16 v[232:235], v[212:213], v[164:165], 0
  v_mfma_f32_16x16x16_bf16 v[236:239], v[214:215], v[164:165], 0
  v_mfma_f32_16x16x16_bf16 v[240:243], v[216:217], v[164:165], 0
  v_mfma_f32_16x16x16_bf16 v[244:247], v[218:219], v[164:165], 0
  v_mfma_f32_16x16x16_bf16 v[248:251], v[220:221], v[164:165], 0
  s_nop 7
  v_add_u32 v224, 0x80, v224
  v_and_or_b32 v224, v224, s66, v63
  v_add_u32 v225, 0x80, v225
  v_and_or_b32 v225, v225, s66, v63
  v_add_u32 v226, 0x80, v226
  v_and_or_b32 v226, v226, s66, v63
  v_add_u32 v227, 0x80, v227
  v_and_or_b32 v227, v227, s66, v63
  v_add_u32 v228, 0x80, v228
  v_and_or_b32 v228, v228, s66, v63
  v_add_u32 v229, 0x80, v229
  v_and_or_b32 v229, v229, s66, v63
  v_add_u32 v230, 0x80, v230
  v_and_or_b32 v230, v230, s66, v63
  v_add_u32 v231, 0x80, v231
  v_and_or_b32 v231, v231, s66, v63
  v_add_u32 v232, 0x80, v232
  v_and_or_b32 v232, v232, s66, v63
  v_add_u32 v233, 0x80, v233
  v_and_or_b32 v233, v233, s66, v63
  v_add_u32 v234, 0x80, v234
  v_and_or_b32 v234, v234, s66, v63
  v_add_u32 v235, 0x80, v235
  v_and_or_b32 v235, v235, s66, v63
  v_add_u32 v236, 0x80, v236
  v_and_or_b32 v236, v236, s66, v63
  v_add_u32 v237, 0x80, v237
  v_and_or_b32 v237, v237, s66, v63
  v_add_u32 v238, 0x80, v238
  v_and_or_b32 v238, v238, s66, v63
  v_add_u32 v239, 0x80, v239
  v_and_or_b32 v239, v239, s66, v63
  v_add_u32 v240, 0x80, v240
  v_and_or_b32 v240, v240, s66, v63
  v_add_u32 v241, 0x80, v241
  v_and_or_b32 v241, v241, s66, v63
  v_add_u32 v242, 0x80, v242
  v_and_or_b32 v242, v242, s66, v63
  v_add_u32 v243, 0x80, v243
  v_and_or_b32 v243, v243, s66, v63
  v_add_u32 v244, 0x80, v244
  v_and_or_b32 v244, v244, s66, v63
  v_add_u32 v245, 0x80, v245
  v_and_or_b32 v245, v245, s66, v63
  v_add_u32 v246, 0x80, v246
  v_and_or_b32 v246, v246, s66, v63
  v_add_u32 v247, 0x80, v247
  v_and_or_b32 v247, v247, s66, v63
  v_add_u32 v248, 0x80, v248
  v_and_or_b32 v248, v248, s66, v63
  v_add_u32 v249, 0x80, v249
  v_and_or_b32 v249, v249, s66, v63
  v_add_u32 v250, 0x80, v250
  v_and_or_b32 v250, v250, s66, v63
  v_add_u32 v251, 0x80, v251
  v_and_or_b32 v251, v251, s66, v63
  s_mov_b64 exec, s[98:99]
  buffer_store_dwordx4 v[224:227], v201, s[36:39], s68 offen offset:0 sc1
  buffer_store_dwordx4 v[228:231], v201, s[36:39], s68 offen offset:64 sc1
  buffer_store_dwordx4 v[232:235], v201, s[36:39], s68 offen offset:128 sc1
  buffer_store_dwordx4 v[236:239], v201, s[36:39], s68 offen offset:192 sc1
  buffer_store_dwordx4 v[240:243], v201, s[36:39], s68 offen offset:256 sc1
  buffer_store_dwordx4 v[244:247], v201, s[36:39], s68 offen offset:320 sc1
  buffer_store_dwordx4 v[248:251], v201, s[36:39], s68 offen offset:384 sc1
  s_mov_b64 exec, -1
L_st2_done:
  s_waitcnt vmcnt(24)
  ds_read_b128 v[64:67], v25 offset:24576
  ds_read_b128 v[68:71], v26 offset:24576
  ds_read_b128 v[72:75], v27 offset:24576
  ds_read_b128 v[76:79], v28 offset:24576
  ds_read_b128 v[80:83], v25 offset:24832
  ds_read_b128 v[84:87], v26 offset:24832
  ds_read_b128 v[88:91], v27 offset:24832
  ds_read_b128 v[92:95], v28 offset:24832
  s_waitcnt lgkmcnt(0)
  s_add_u32 m0, s72, 24576
  s_nop 0
  buffer_load_dwordx4 v18, s[56:59], s73 offen  lds
  s_add_u32 m0, s72, 25600
  s_nop 0
  buffer_load_dwordx4 v19, s[56:59], s73 offen  lds
  s_add_u32 m0, s72, 26624
  s_nop 0
  buffer_load_dwordx4 v20, s[56:59], s73 offen  lds
  s_add_u32 m0, s72, 27648
  s_nop 0
  buffer_load_dwordx4 v21, s[56:59], s73 offen  lds
  s_add_u32 m0, s72, 28672
  s_nop 0
  buffer_load_dwordx4 v22, s[56:59], s73 offen  lds
  s_add_u32 m0, s72, 29696
  s_nop 0
  buffer_load_dwordx4 v23, s[56:59], s73 offen  lds
  s_add_u32 m0, s72, 30720
  s_nop 0
  buffer_load_dwordx4 v24, s[56:59], s73 offen  lds
  s_add_u32 s73, s73, 28672
  v_mfma_f32_16x16x32_bf16 v[44:47], v[64:67], v[96:99], 0
  v_mfma_f32_16x16x32_bf16 v[44:47], v[68:71], v[100:103], v[44:47]
  v_mfma_f32_16x16x32_bf16 v[44:47], v[72:75], v[104:107], v[44:47]
  v_mfma_f32_16x16x32_bf16 v[44:47], v[76:79], v[108:111], v[44:47]
  v_mfma_f32_16x16x32_bf16 v[44:47], v[80:83], v[112:115], v[44:47]
  v_mfma_f32_16x16x32_bf16 v[44:47], v[84:87], v[116:119], v[44:47]
  v_mfma_f32_16x16x32_bf16 v[44:47], v[88:91], v[120:123], v[44:47]
  v_mfma_f32_16x16x32_bf16 v[44:47], v[92:95], v[124:127], v[44:47]
  s_nop 7
  v_max3_f32 v60, v60, v44, v45
  v_cvt_pk_bf16_f32 v152, v44, v45
  v_max3_f32 v60, v60, v46, v47
  v_cvt_pk_bf16_f32 v153, v46, v47
  s_waitcnt vmcnt(23)
  ds_read_b128 v[64:67], v25 offset:0
  ds_read_b128 v[68:71], v26 offset:0
  ds_read_b128 v[72:75], v27 offset:0
  ds_read_b128 v[76:79], v28 offset:0
  ds_read_b128 v[80:83], v25 offset:256
  ds_read_b128 v[84:87], v26 offset:256
  ds_read_b128 v[88:91], v27 offset:256
  ds_read_b128 v[92:95], v28 offset:256
  s_waitcnt lgkmcnt(0)
  s_add_u32 s69, s70, 0
  s_add_u32 m0, s72, 0
  s_nop 0
  buffer_load_dwordx4 v10, s[32:35], s69 offen offset:0 nt lds
  buffer_load_dwordx4 v11, s[32:35], s69 offen offset:1024 nt lds
  buffer_load_dwordx4 v12, s[32:35], s69 offen offset:2048 nt lds
  buffer_load_dwordx4 v13, s[32:35], s69 offen offset:3072 nt lds
  s_add_u32 m0, s72, 4096
  s_nop 0
  buffer_load_dwordx4 v14, s[32:35], s69 offen offset:0 nt lds
  buffer_load_dwordx4 v15, s[32:35], s69 offen offset:1024 nt lds
  buffer_load_dwordx4 v16, s[32:35], s69 offen offset:2048 nt lds
  buffer_load_dwordx4 v17, s[32:35], s69 offen offset:3072 nt lds
  v_mfma_f32_16x16x32_bf16 v[48:51], v[64:67], v[96:99], 0
  v_mfma_f32_16x16x32_bf16 v[48:51], v[68:71], v[100:103], v[48:51]
  v_mfma_f32_16x16x32_bf16 v[48:51], v[72:75], v[104:107], v[48:51]
  v_mfma_f32_16x16x32_bf16 v[48:51], v[76:79], v[108:111], v[48:51]
  v_mfma_f32_16x16x32_bf16 v[48:51], v[80:83], v[112:115], v[48:51]
  v_mfma_f32_16x16x32_bf16 v[48:51], v[84:87], v[116:119], v[48:51]
  v_mfma_f32_16x16x32_bf16 v[48:51], v[88:91], v[120:123], v[48:51]
  v_mfma_f32_16x16x32_bf16 v[48:51], v[92:95], v[124:127], v[48:51]
  s_nop 7
  v_max3_f32 v60, v60, v48, v49
  v_cvt_pk_bf16_f32 v154, v48, v49
  v_max3_f32 v60, v60, v50, v51
  v_cvt_pk_bf16_f32 v155, v50, v51
  s_waitcnt vmcnt(23)
  ds_read_b128 v[64:67], v25 offset:8192
  ds_read_b128 v[68:71], v26 offset:8192
  ds_read_b128 v[72:75], v27 offset:8192
  ds_read_b128 v[76:79], v28 offset:8192
  ds_read_b128 v[80:83], v25 offset:8448
  ds_read_b128 v[84:87], v26 offset:8448
  ds_read_b128 v[88:91], v27 offset:8448
  ds_read_b128 v[92:95], v28 offset:8448
  s_waitcnt lgkmcnt(0)
  s_add_u32 s69, s70, 65536
  s_add_u32 m0, s72, 8192
  s_nop 0
  buffer_load_dwordx4 v10, s[32:35], s69 offen offset:0 nt lds
  buffer_load_dwordx4 v11, s[32:35], s69 offen offset:1024 nt lds
  buffer_load_dwordx4 v12, s[32:35], s69 offen offset:2048 nt lds
  buffer_load_dwordx4 v13, s[32:35], s69 offen offset:3072 nt lds
  s_add_u32 m0, s72, 12288
  s_nop 0
  buffer_load_dwordx4 v14, s[32:35], s69 offen offset:0 nt lds
  buffer_load_dwordx4 v15, s[32:35], s69 offen offset:1024 nt lds
  buffer_load_dwordx4 v16, s[32:35], s69 offen offset:2048 nt lds
  buffer_load_dwordx4 v17, s[32:35], s69 offen offset:3072 nt lds
  v_mfma_f32_16x16x32_bf16 v[44:47], v[64:67], v[96:99], 0
  v_mfma_f32_16x16x32_bf16 v[44:47], v[68:71], v[100:103], v[44:47]
  v_mfma_f32_16x16x32_bf16 v[44:47], v[72:75], v[104:107], v[44:47]
  v_mfma_f32_16x16x32_bf16 v[44:47], v[76:79], v[108:111], v[44:47]
  v_mfma_f32_16x16x32_bf16 v[44:47], v[80:83], v[112:115], v[44:47]
  v_mfma_f32_16x16x32_bf16 v[44:47], v[84:87], v[116:119], v[44:47]
  v_mfma_f32_16x16x32_bf16 v[44:47], v[88:91], v[120:123], v[44:47]
  v_mfma_f32_16x16x32_bf16 v[44:47], v[92:95], v[124:127], v[44:47]
  s_nop 7
  v_max3_f32 v60, v60, v44, v45
  v_cvt_pk_bf16_f32 v156, v44, v45
  v_max3_f32 v60, v60, v46, v47
  v_cvt_pk_bf16_f32 v157, v46, v47
  s_waitcnt vmcnt(23)
  ds_read_b128 v[64:67], v25 offset:16384
  ds_read_b128 v[68:71], v26 offset:16384
  ds_read_b128 v[72:75], v27 offset:16384
  ds_read_b128 v[76:79], v28 offset:16384
  ds_read_b128 v[80:83], v25 offset:16640
  ds_read_b128 v[84:87], v26 offset:16640
  ds_read_b128 v[88:91], v27 offset:16640
  ds_read_b128 v[92:95], v28 offset:16640
  s_waitcnt lgkmcnt(0)
  s_add_u32 s69, s70, 131072
  s_add_u32 m0, s72, 16384
  s_nop 0
  buffer_load_dwordx4 v10, s[32:35], s69 offen offset:0 nt lds
  buffer_load_dwordx4 v11, s[32:35], s69 offen offset:1024 nt lds
  buffer_load_dwordx4 v12, s[32:35], s69 offen offset:2048 nt lds
  buffer_load_dwordx4 v13, s[32:35], s69 offen offset:3072 nt lds
  s_add_u32 m0, s72, 20480
  s_nop 0
  buffer_load_dwordx4 v14, s[32:35], s69 offen offset:0 nt lds
  buffer_load_dwordx4 v15, s[32:35], s69 offen offset:1024 nt lds
  buffer_load_dwordx4 v16, s[32:35], s69 offen offset:2048 nt lds
  buffer_load_dwordx4 v17, s[32:35], s69 offen offset:3072 nt lds
  v_mfma_f32_16x16x32_bf16 v[48:51], v[64:67], v[96:99], 0
  v_mfma_f32_16x16x32_bf16 v[48:51], v[68:71], v[100:103], v[48:51]
  v_mfma_f32_16x16x32_bf16 v[48:51], v[72:75], v[104:107], v[48:51]
  v_mfma_f32_16x16x32_bf16 v[48:51], v[76:79], v[108:111], v[48:51]
  v_mfma_f32_16x16x32_bf16 v[48:51], v[80:83], v[112:115], v[48:51]
  v_mfma_f32_16x16x32_bf16 v[48:51], v[84:87], v[116:119], v[48:51]
  v_mfma_f32_16x16x32_bf16 v[48:51], v[88:91], v[120:123], v[48:51]
  v_mfma_f32_16x16x32_bf16 v[48:51], v[92:95], v[124:127], v[48:51]
  s_nop 7
  v_max3_f32 v60, v60, v48, v49
  v_cvt_pk_bf16_f32 v158, v48, v49
  v_max3_f32 v60, v60, v50, v51
  v_cvt_pk_bf16_f32 v159, v50, v51
  s_waitcnt vmcnt(24)
  ds_read_b64_tr_b16 a[76:77], v40 offset:24576
  ds_read_b64_tr_b16 a[78:79], v40 offset:25472
  ds_read_b64_tr_b16 a[92:93], v40 offset:24608
  ds_read_b64_tr_b16 a[94:95], v40 offset:25504
  ds_read_b64_tr_b16 a[108:109], v40 offset:24640
  ds_read_b64_tr_b16 a[110:111], v40 offset:25536
  ds_read_b64_tr_b16 a[124:125], v40 offset:24672
  ds_read_b64_tr_b16 a[126:127], v40 offset:25568
  ds_read_b64_tr_b16 a[140:141], v40 offset:24704
  ds_read_b64_tr_b16 a[142:143], v40 offset:25600
  ds_read_b64_tr_b16 a[156:157], v40 offset:24736
  ds_read_b64_tr_b16 a[158:159], v40 offset:25632
  ds_read_b64_tr_b16 a[172:173], v40 offset:24768
  ds_read_b64_tr_b16 a[174:175], v40 offset:25664
  s_waitcnt lgkmcnt(0)
  s_add_u32 s69, s70, 196608
  s_add_u32 m0, s72, 24576
  s_nop 0
  buffer_load_dwordx4 v10, s[32:35], s69 offen offset:0 nt lds
  buffer_load_dwordx4 v11, s[32:35], s69 offen offset:1024 nt lds
  buffer_load_dwordx4 v12, s[32:35], s69 offen offset:2048 nt lds
  buffer_load_dwordx4 v13, s[32:35], s69 offen offset:3072 nt lds
  s_add_u32 m0, s72, 28672
  s_nop 0
  buffer_load_dwordx4 v14, s[32:35], s69 offen offset:0 nt lds
  buffer_load_dwordx4 v15, s[32:35], s69 offen offset:1024 nt lds
  buffer_load_dwordx4 v16, s[32:35], s69 offen offset:2048 nt lds
  buffer_load_dwordx4 v17, s[32:35], s69 offen offset:3072 nt lds
  v_mov_b32 v61, v60
  s_nop 1
  v_permlane16_swap_b32 v60, v61
  s_nop 1
  v_max_f32 v60, v60, v61
  v_mov_b32 v61, v60
  s_nop 1
  v_permlane32_swap_b32 v60, v61
  s_nop 1
  v_max_f32 v60, v60, v61
  v_cvt_pk_bf16_f32 v60, v60, v60
  v_and_b32 v60, 0xffff0000, v60
  s_mov_b32 s98, 0x3db8aa3b
  v_mul_f32 v61, s98, v60
  v_sub_f32 v61, 0, v61
  v_mov_b32 v62, 0
  v_mov_b32 v59, 0
  v_lshlrev_b32 v44, 16, v128
  v_and_b32 v45, 0xffff0000, v128
  v_lshlrev_b32 v48, 16, v129
  v_and_b32 v49, 0xffff0000, v129
  v_fma_f32 v44, v44, s98, v61
  v_fma_f32 v45, v45, s98, v61
  v_fma_f32 v48, v48, s98, v61
  v_fma_f32 v49, v49, s98, v61
  v_exp_f32 v44, v44
  v_exp_f32 v45, v45
  v_exp_f32 v48, v48
  v_exp_f32 v49, v49
  s_nop 0
  v_add_f32 v62, v62, v44
  v_add_f32 v59, v59, v45
  v_cvt_pk_bf16_f32 v128, v44, v45
  v_add_f32 v62, v62, v48
  v_add_f32 v59, v59, v49
  v_cvt_pk_bf16_f32 v129, v48, v49
  v_lshlrev_b32 v44, 16, v130
  v_and_b32 v45, 0xffff0000, v130
  v_lshlrev_b32 v48, 16, v131
  v_and_b32 v49, 0xffff0000, v131
  v_fma_f32 v44, v44, s98, v61
  v_fma_f32 v45, v45, s98, v61
  v_fma_f32 v48, v48, s98, v61
  v_fma_f32 v49, v49, s98, v61
  v_exp_f32 v44, v44
  v_exp_f32 v45, v45
  v_exp_f32 v48, v48
  v_exp_f32 v49, v49
  s_nop 0
  v_add_f32 v62, v62, v44
  v_add_f32 v59, v59, v45
  v_cvt_pk_bf16_f32 v130, v44, v45
  v_add_f32 v62, v62, v48
  v_add_f32 v59, v59, v49
  v_cvt_pk_bf16_f32 v131, v48, v49
  v_lshlrev_b32 v44, 16, v132
  v_and_b32 v45, 0xffff0000, v132
  v_lshlrev_b32 v48, 16, v133
  v_and_b32 v49, 0xffff0000, v133
  v_fma_f32 v44, v44, s98, v61
  v_fma_f32 v45, v45, s98, v61
  v_fma_f32 v48, v48, s98, v61
  v_fma_f32 v49, v49, s98, v61
  v_exp_f32 v44, v44
  v_exp_f32 v45, v45
  v_exp_f32 v48, v48
  v_exp_f32 v49, v49
  s_nop 0
  v_add_f32 v62, v62, v44
  v_add_f32 v59, v59, v45
  v_cvt_pk_bf16_f32 v132, v44, v45
  v_add_f32 v62, v62, v48
  v_add_f32 v59, v59, v49
  v_cvt_pk_bf16_f32 v133, v48, v49
  v_lshlrev_b32 v44, 16, v134
  v_and_b32 v45, 0xffff0000, v134
  v_lshlrev_b32 v48, 16, v135
  v_and_b32 v49, 0xffff0000, v135
  v_fma_f32 v44, v44, s98, v61
  v_fma_f32 v45, v45, s98, v61
  v_fma_f32 v48, v48, s98, v61
  v_fma_f32 v49, v49, s98, v61
  v_exp_f32 v44, v44
  v_exp_f32 v45, v45
  v_exp_f32 v48, v48
  v_exp_f32 v49, v49
  s_nop 0
  v_add_f32 v62, v62, v44
  v_add_f32 v59, v59, v45
  v_cvt_pk_bf16_f32 v134, v44, v45
  v_add_f32 v62, v62, v48
  v_add_f32 v59, v59, v49
  v_cvt_pk_bf16_f32 v135, v48, v49
  v_lshlrev_b32 v44, 16, v136
  v_and_b32 v45, 0xffff0000, v136
  v_lshlrev_b32 v48, 16, v137
  v_and_b32 v49, 0xffff0000, v137
  v_fma_f32 v44, v44, s98, v61
  v_fma_f32 v45, v45, s98, v61
  v_fma_f32 v48, v48, s98, v61
  v_fma_f32 v49, v49, s98, v61
  v_exp_f32 v44, v44
  v_exp_f32 v45, v45
  v_exp_f32 v48, v48
  v_exp_f32 v49, v49
  s_nop 0
  v_add_f32 v62, v62, v44
  v_add_f32 v59, v59, v45
  v_cvt_pk_bf16_f32 v136, v44, v45
  v_add_f32 v62, v62, v48
  v_add_f32 v59, v59, v49
  v_cvt_pk_bf16_f32 v137, v48, v49
  v_lshlrev_b32 v44, 16, v138
  v_and_b32 v45, 0xffff0000, v138
  v_lshlrev_b32 v48, 16, v139
  v_and_b32 v49, 0xffff0000, v139
  v_fma_f32 v44, v44, s98, v61
  v_fma_f32 v45, v45, s98, v61
  v_fma_f32 v48, v48, s98, v61
  v_fma_f32 v49, v49, s98, v61
  v_exp_f32 v44, v44
  v_exp_f32 v45, v45
  v_exp_f32 v48, v48
  v_exp_f32 v49, v49
  s_nop 0
  v_add_f32 v62, v62, v44
  v_add_f32 v59, v59, v45
  v_cvt_pk_bf16_f32 v138, v44, v45
  v_add_f32 v62, v62, v48
  v_add_f32 v59, v59, v49
  v_cvt_pk_bf16_f32 v139, v48, v49
  v_lshlrev_b32 v44, 16, v140
  v_and_b32 v45, 0xffff0000, v140
  v_lshlrev_b32 v48, 16, v141
  v_and_b32 v49, 0xffff0000, v141
  v_fma_f32 v44, v44, s98, v61
  v_fma_f32 v45, v45, s98, v61
  v_fma_f32 v48, v48, s98, v61
  v_fma_f32 v49, v49, s98, v61
  v_exp_f32 v44, v44
  v_exp_f32 v45, v45
  v_exp_f32 v48, v48
  v_exp_f32 v49, v49
  s_nop 0
  v_add_f32 v62, v62, v44
  v_add_f32 v59, v59, v45
  v_cvt_pk_bf16_f32 v140, v44, v45
  v_add_f32 v62, v62, v48
  v_add_f32 v59, v59, v49
  v_cvt_pk_bf16_f32 v141, v48, v49
  v_lshlrev_b32 v44, 16, v142
  v_and_b32 v45, 0xffff0000, v142
  v_lshlrev_b32 v48, 16, v143
  v_and_b32 v49, 0xffff0000, v143
  v_fma_f32 v44, v44, s98, v61
  v_fma_f32 v45, v45, s98, v61
  v_fma_f32 v48, v48, s98, v61
  v_fma_f32 v49, v49, s98, v61
  v_exp_f32 v44, v44
  v_exp_f32 v45, v45
  v_exp_f32 v48, v48
  v_exp_f32 v49, v49
  s_nop 0
  v_add_f32 v62, v62, v44
  v_add_f32 v59, v59, v45
  v_cvt_pk_bf16_f32 v142, v44, v45
  v_add_f32 v62, v62, v48
  v_add_f32 v59, v59, v49
  v_cvt_pk_bf16_f32 v143, v48, v49
  v_lshlrev_b32 v44, 16, v144
  v_and_b32 v45, 0xffff0000, v144
  v_lshlrev_b32 v48, 16, v145
  v_and_b32 v49, 0xffff0000, v145
  v_fma_f32 v44, v44, s98, v61
  v_fma_f32 v45, v45, s98, v61
  v_fma_f32 v48, v48, s98, v61
  v_fma_f32 v49, v49, s98, v61
  v_exp_f32 v44, v44
  v_exp_f32 v45, v45
  v_exp_f32 v48, v48
  v_exp_f32 v49, v49
  s_nop 0
  v_add_f32 v62, v62, v44
  v_add_f32 v59, v59, v45
  v_cvt_pk_bf16_f32 v144, v44, v45
  v_add_f32 v62, v62, v48
  v_add_f32 v59, v59, v49
  v_cvt_pk_bf16_f32 v145, v48, v49
  v_lshlrev_b32 v44, 16, v146
  v_and_b32 v45, 0xffff0000, v146
  v_lshlrev_b32 v48, 16, v147
  v_and_b32 v49, 0xffff0000, v147
  v_fma_f32 v44, v44, s98, v61
  v_fma_f32 v45, v45, s98, v61
  v_fma_f32 v48, v48, s98, v61
  v_fma_f32 v49, v49, s98, v61
  v_exp_f32 v44, v44
  v_exp_f32 v45, v45
  v_exp_f32 v48, v48
  v_exp_f32 v49, v49
  s_nop 0
  v_add_f32 v62, v62, v44
  v_add_f32 v59, v59, v45
  v_cvt_pk_bf16_f32 v146, v44, v45
  v_add_f32 v62, v62, v48
  v_add_f32 v59, v59, v49
  v_cvt_pk_bf16_f32 v147, v48, v49
  v_lshlrev_b32 v44, 16, v148
  v_and_b32 v45, 0xffff0000, v148
  v_lshlrev_b32 v48, 16, v149
  v_and_b32 v49, 0xffff0000, v149
  v_fma_f32 v44, v44, s98, v61
  v_fma_f32 v45, v45, s98, v61
  v_fma_f32 v48, v48, s98, v61
  v_fma_f32 v49, v49, s98, v61
  v_exp_f32 v44, v44
  v_exp_f32 v45, v45
  v_exp_f32 v48, v48
  v_exp_f32 v49, v49
  s_nop 0
  v_add_f32 v62, v62, v44
  v_add_f32 v59, v59, v45
  v_cvt_pk_bf16_f32 v148, v44, v45
  v_add_f32 v62, v62, v48
  v_add_f32 v59, v59, v49
  v_cvt_pk_bf16_f32 v149, v48, v49
  v_lshlrev_b32 v44, 16, v150
  v_and_b32 v45, 0xffff0000, v150
  v_lshlrev_b32 v48, 16, v151
  v_and_b32 v49, 0xffff0000, v151
  v_fma_f32 v44, v44, s98, v61
  v_fma_f32 v45, v45, s98, v61
  v_fma_f32 v48, v48, s98, v61
  v_fma_f32 v49, v49, s98, v61
  v_exp_f32 v44, v44
  v_exp_f32 v45, v45
  v_exp_f32 v48, v48
  v_exp_f32 v49, v49
  s_nop 0
  v_add_f32 v62, v62, v44
  v_add_f32 v59, v59, v45
  v_cvt_pk_bf16_f32 v150, v44, v45
  v_add_f32 v62, v62, v48
  v_add_f32 v59, v59, v49
  v_cvt_pk_bf16_f32 v151, v48, v49
  v_lshlrev_b32 v44, 16, v152
  v_and_b32 v45, 0xffff0000, v152
  v_lshlrev_b32 v48, 16, v153
  v_and_b32 v49, 0xffff0000, v153
  v_fma_f32 v44, v44, s98, v61
  v_fma_f32 v45, v45, s98, v61
  v_fma_f32 v48, v48, s98, v61
  v_fma_f32 v49, v49, s98, v61
  v_exp_f32 v44, v44
  v_exp_f32 v45, v45
  v_exp_f32 v48, v48
  v_exp_f32 v49, v49
  s_nop 0
  v_add_f32 v62, v62, v44
  v_add_f32 v59, v59, v45
  v_cvt_pk_bf16_f32 v152, v44, v45
  v_add_f32 v62, v62, v48
  v_add_f32 v59, v59, v49
  v_cvt_pk_bf16_f32 v153, v48, v49
  v_lshlrev_b32 v44, 16, v154
  v_and_b32 v45, 0xffff0000, v154
  v_lshlrev_b32 v48, 16, v155
  v_and_b32 v49, 0xffff0000, v155
  v_fma_f32 v44, v44, s98, v61
  v_fma_f32 v45, v45, s98, v61
  v_fma_f32 v48, v48, s98, v61
  v_fma_f32 v49, v49, s98, v61
  v_exp_f32 v44, v44
  v_exp_f32 v45, v45
  v_exp_f32 v48, v48
  v_exp_f32 v49, v49
  s_nop 0
  v_add_f32 v62, v62, v44
  v_add_f32 v59, v59, v45
  v_cvt_pk_bf16_f32 v154, v44, v45
  v_add_f32 v62, v62, v48
  v_add_f32 v59, v59, v49
  v_cvt_pk_bf16_f32 v155, v48, v49
  v_lshlrev_b32 v44, 16, v156
  v_and_b32 v45, 0xffff0000, v156
  v_lshlrev_b32 v48, 16, v157
  v_and_b32 v49, 0xffff0000, v157
  v_fma_f32 v44, v44, s98, v61
  v_fma_f32 v45, v45, s98, v61
  v_fma_f32 v48, v48, s98, v61
  v_fma_f32 v49, v49, s98, v61
  v_exp_f32 v44, v44
  v_exp_f32 v45, v45
  v_exp_f32 v48, v48
  v_exp_f32 v49, v49
  s_nop 0
  v_add_f32 v62, v62, v44
  v_add_f32 v59, v59, v45
  v_cvt_pk_bf16_f32 v156, v44, v45
  v_add_f32 v62, v62, v48
  v_add_f32 v59, v59, v49
  v_cvt_pk_bf16_f32 v157, v48, v49
  v_lshlrev_b32 v44, 16, v158
  v_and_b32 v45, 0xffff0000, v158
  v_lshlrev_b32 v48, 16, v159
  v_and_b32 v49, 0xffff0000, v159
  v_fma_f32 v44, v44, s98, v61
  v_fma_f32 v45, v45, s98, v61
  v_fma_f32 v48, v48, s98, v61
  v_fma_f32 v49, v49, s98, v61
  v_exp_f32 v44, v44
  v_exp_f32 v45, v45
  v_exp_f32 v48, v48
  v_exp_f32 v49, v49
  s_nop 0
  v_add_f32 v62, v62, v44
  v_add_f32 v59, v59, v45
  v_cvt_pk_bf16_f32 v158, v44, v45
  v_add_f32 v62, v62, v48
  v_add_f32 v59, v59, v49
  v_cvt_pk_bf16_f32 v159, v48, v49
  v_add_f32 v62, v62, v59
  v_mov_b32 v61, v62
  s_nop 1
  v_permlane16_swap_b32 v62, v61
  s_nop 1
  v_add_f32 v62, v62, v61
  v_mov_b32 v61, v62
  s_nop 1
  v_permlane32_swap_b32 v62, v61
  s_nop 1
  v_add_f32 v62, v62, v61
  s_waitcnt vmcnt(24)
  ds_read_b64_tr_b16 v[64:65], v29 offset:0
  ds_read_b64_tr_b16 v[66:67], v30 offset:0
  ds_read_b64_tr_b16 v[68:69], v31 offset:0
  ds_read_b64_tr_b16 v[70:71], v32 offset:0
  ds_read_b64_tr_b16 v[72:73], v33 offset:0
  ds_read_b64_tr_b16 v[74:75], v34 offset:0
  ds_read_b64_tr_b16 v[76:77], v35 offset:0
  ds_read_b64_tr_b16 v[78:79], v36 offset:0
  ds_read_b64_tr_b16 v[80:81], v29 offset:256
  ds_read_b64_tr_b16 v[82:83], v30 offset:256
  ds_read_b64_tr_b16 v[84:85], v31 offset:256
  ds_read_b64_tr_b16 v[86:87], v32 offset:256
  ds_read_b64_tr_b16 v[88:89], v33 offset:256
  ds_read_b64_tr_b16 v[90:91], v34 offset:256
  ds_read_b64_tr_b16 v[92:93], v35 offset:256
  ds_read_b64_tr_b16 v[94:95], v36 offset:256
  s_waitcnt lgkmcnt(0)
  s_add_u32 s69, s70, 262144
  s_add_u32 m0, s72, 0
  s_nop 0
  buffer_load_dwordx4 v10, s[32:35], s69 offen offset:0 nt lds
  buffer_load_dwordx4 v11, s[32:35], s69 offen offset:1024 nt lds
  buffer_load_dwordx4 v12, s[32:35], s69 offen offset:2048 nt lds
  buffer_load_dwordx4 v13, s[32:35], s69 offen offset:3072 nt lds
  s_add_u32 m0, s72, 4096
  s_nop 0
  buffer_load_dwordx4 v14, s[32:35], s69 offen offset:0 nt lds
  buffer_load_dwordx4 v15, s[32:35], s69 offen offset:1024 nt lds
  buffer_load_dwordx4 v16, s[32:35], s69 offen offset:2048 nt lds
  buffer_load_dwordx4 v17, s[32:35], s69 offen offset:3072 nt lds
  v_mfma_f32_16x16x16_bf16 a[0:3], v[64:65], v[128:129], 0
  v_mfma_f32_16x16x16_bf16 a[4:7], v[66:67], v[128:129], 0
  v_mfma_f32_16x16x16_bf16 a[8:11], v[68:69], v[128:129], 0
  v_mfma_f32_16x16x16_bf16 a[12:15], v[70:71], v[128:129], 0
  v_mfma_f32_16x16x16_bf16 a[16:19], v[72:73], v[128:129], 0
  v_mfma_f32_16x16x16_bf16 a[20:23], v[74:75], v[128:129], 0
  v_mfma_f32_16x16x16_bf16 a[24:27], v[76:77], v[128:129], 0
  v_mfma_f32_16x16x16_bf16 a[28:31], v[78:79], v[128:129], 0
  v_mfma_f32_16x16x16_bf16 a[32:35], v[80:81], v[128:129], 0
  v_mfma_f32_16x16x16_bf16 a[36:39], v[82:83], v[128:129], 0
  v_mfma_f32_16x16x16_bf16 a[40:43], v[84:85], v[128:129], 0
  v_mfma_f32_16x16x16_bf16 a[44:47], v[86:87], v[128:129], 0
  v_mfma_f32_16x16x16_bf16 a[48:51], v[88:89], v[128:129], 0
  v_mfma_f32_16x16x16_bf16 a[52:55], v[90:91], v[128:129], 0
  v_mfma_f32_16x16x16_bf16 a[56:59], v[92:93], v[128:129], 0
  v_mfma_f32_16x16x16_bf16 a[60:63], v[94:95], v[128:129], 0
  s_waitcnt vmcnt(24)
  ds_read_b64_tr_b16 v[64:65], v29 offset:8192
  ds_read_b64_tr_b16 v[66:67], v30 offset:8192
  ds_read_b64_tr_b16 v[68:69], v31 offset:8192
  ds_read_b64_tr_b16 v[70:71], v32 offset:8192
  ds_read_b64_tr_b16 v[72:73], v33 offset:8192
  ds_read_b64_tr_b16 v[74:75], v34 offset:8192
  ds_read_b64_tr_b16 v[76:77], v35 offset:8192
  ds_read_b64_tr_b16 v[78:79], v36 offset:8192
  ds_read_b64_tr_b16 v[80:81], v29 offset:8448
  ds_read_b64_tr_b16 v[82:83], v30 offset:8448
  ds_read_b64_tr_b16 v[84:85], v31 offset:8448
  ds_read_b64_tr_b16 v[86:87], v32 offset:8448
  ds_read_b64_tr_b16 v[88:89], v33 offset:8448
  ds_read_b64_tr_b16 v[90:91], v34 offset:8448
  ds_read_b64_tr_b16 v[92:93], v35 offset:8448
  ds_read_b64_tr_b16 v[94:95], v36 offset:8448
  s_waitcnt lgkmcnt(0)
  s_add_u32 s69, s70, 327680
  s_add_u32 m0, s72, 8192
  s_nop 0
  buffer_load_dwordx4 v10, s[32:35], s69 offen offset:0 nt lds
  buffer_load_dwordx4 v11, s[32:35], s69 offen offset:1024 nt lds
  buffer_load_dwordx4 v12, s[32:35], s69 offen offset:2048 nt lds
  buffer_load_dwordx4 v13, s[32:35], s69 offen offset:3072 nt lds
  s_add_u32 m0, s72, 12288
  s_nop 0
  buffer_load_dwordx4 v14, s[32:35], s69 offen offset:0 nt lds
  buffer_load_dwordx4 v15, s[32:35], s69 offen offset:1024 nt lds
  buffer_load_dwordx4 v16, s[32:35], s69 offen offset:2048 nt lds
  buffer_load_dwordx4 v17, s[32:35], s69 offen offset:3072 nt lds
  v_mfma_f32_16x16x16_bf16 a[0:3], v[64:65], v[130:131], a[0:3]
  v_mfma_f32_16x16x16_bf16 a[4:7], v[66:67], v[130:131], a[4:7]
  v_mfma_f32_16x16x16_bf16 a[8:11], v[68:69], v[130:131], a[8:11]
  v_mfma_f32_16x16x16_bf16 a[12:15], v[70:71], v[130:131], a[12:15]
  v_mfma_f32_16x16x16_bf16 a[16:19], v[72:73], v[130:131], a[16:19]
  v_mfma_f32_16x16x16_bf16 a[20:23], v[74:75], v[130:131], a[20:23]
  v_mfma_f32_16x16x16_bf16 a[24:27], v[76:77], v[130:131], a[24:27]
  v_mfma_f32_16x16x16_bf16 a[28:31], v[78:79], v[130:131], a[28:31]
  v_mfma_f32_16x16x16_bf16 a[32:35], v[80:81], v[130:131], a[32:35]
  v_mfma_f32_16x16x16_bf16 a[36:39], v[82:83], v[130:131], a[36:39]
  v_mfma_f32_16x16x16_bf16 a[40:43], v[84:85], v[130:131], a[40:43]
  v_mfma_f32_16x16x16_bf16 a[44:47], v[86:87], v[130:131], a[44:47]
  v_mfma_f32_16x16x16_bf16 a[48:51], v[88:89], v[130:131], a[48:51]
  v_mfma_f32_16x16x16_bf16 a[52:55], v[90:91], v[130:131], a[52:55]
  v_mfma_f32_16x16x16_bf16 a[56:59], v[92:93], v[130:131], a[56:59]
  v_mfma_f32_16x16x16_bf16 a[60:63], v[94:95], v[130:131], a[60:63]
  s_waitcnt vmcnt(24)
  ds_read_b64_tr_b16 v[64:65], v29 offset:16384
  ds_read_b64_tr_b16 v[66:67], v30 offset:16384
  ds_read_b64_tr_b16 v[68:69], v31 offset:16384
  ds_read_b64_tr_b16 v[70:71], v32 offset:16384
  ds_read_b64_tr_b16 v[72:73], v33 offset:16384
  ds_read_b64_tr_b16 v[74:75], v34 offset:16384
  ds_read_b64_tr_b16 v[76:77], v35 offset:16384
  ds_read_b64_tr_b16 v[78:79], v36 offset:16384
  ds_read_b64_tr_b16 v[80:81], v29 offset:16640
  ds_read_b64_tr_b16 v[82:83], v30 offset:16640
  ds_read_b64_tr_b16 v[84:85], v31 offset:16640
  ds_read_b64_tr_b16 v[86:87], v32 offset:16640
  ds_read_b64_tr_b16 v[88:89], v33 offset:16640
  ds_read_b64_tr_b16 v[90:91], v34 offset:16640
  ds_read_b64_tr_b16 v[92:93], v35 offset:16640
  ds_read_b64_tr_b16 v[94:95], v36 offset:16640
  s_waitcnt lgkmcnt(0)
  s_add_u32 s69, s70, 393216
  s_add_u32 m0, s72, 16384
  s_nop 0
  buffer_load_dwordx4 v10, s[32:35], s69 offen offset:0 nt lds
  buffer_load_dwordx4 v11, s[32:35], s69 offen offset:1024 nt lds
  buffer_load_dwordx4 v12, s[32:35], s69 offen offset:2048 nt lds
  buffer_load_dwordx4 v13, s[32:35], s69 offen offset:3072 nt lds
  s_add_u32 m0, s72, 20480
  s_nop 0
  buffer_load_dwordx4 v14, s[32:35], s69 offen offset:0 nt lds
  buffer_load_dwordx4 v15, s[32:35], s69 offen offset:1024 nt lds
  buffer_load_dwordx4 v16, s[32:35], s69 offen offset:2048 nt lds
  buffer_load_dwordx4 v17, s[32:35], s69 offen offset:3072 nt lds
  v_mfma_f32_16x16x16_bf16 a[0:3], v[64:65], v[132:133], a[0:3]
  v_mfma_f32_16x16x16_bf16 a[4:7], v[66:67], v[132:133], a[4:7]
  v_mfma_f32_16x16x16_bf16 a[8:11], v[68:69], v[132:133], a[8:11]
  v_mfma_f32_16x16x16_bf16 a[12:15], v[70:71], v[132:133], a[12:15]
  v_mfma_f32_16x16x16_bf16 a[16:19], v[72:73], v[132:133], a[16:19]
  v_mfma_f32_16x16x16_bf16 a[20:23], v[74:75], v[132:133], a[20:23]
  v_mfma_f32_16x16x16_bf16 a[24:27], v[76:77], v[132:133], a[24:27]
  v_mfma_f32_16x16x16_bf16 a[28:31], v[78:79], v[132:133], a[28:31]
  v_mfma_f32_16x16x16_bf16 a[32:35], v[80:81], v[132:133], a[32:35]
  v_mfma_f32_16x16x16_bf16 a[36:39], v[82:83], v[132:133], a[36:39]
  v_mfma_f32_16x16x16_bf16 a[40:43], v[84:85], v[132:133], a[40:43]
  v_mfma_f32_16x16x16_bf16 a[44:47], v[86:87], v[132:133], a[44:47]
  v_mfma_f32_16x16x16_bf16 a[48:51], v[88:89], v[132:133], a[48:51]
  v_mfma_f32_16x16x16_bf16 a[52:55], v[90:91], v[132:133], a[52:55]
  v_mfma_f32_16x16x16_bf16 a[56:59], v[92:93], v[132:133], a[56:59]
  v_mfma_f32_16x16x16_bf16 a[60:63], v[94:95], v[132:133], a[60:63]
  s_waitcnt vmcnt(24)
  ds_read_b64_tr_b16 v[64:65], v29 offset:24576
  ds_read_b64_tr_b16 v[66:67], v30 offset:24576
  ds_read_b64_tr_b16 v[68:69], v31 offset:24576
  ds_read_b64_tr_b16 v[70:71], v32 offset:24576
  ds_read_b64_tr_b16 v[72:73], v33 offset:24576
  ds_read_b64_tr_b16 v[74:75], v34 offset:24576
  ds_read_b64_tr_b16 v[76:77], v35 offset:24576
  ds_read_b64_tr_b16 v[78:79], v36 offset:24576
  ds_read_b64_tr_b16 v[80:81], v29 offset:24832
  ds_read_b64_tr_b16 v[82:83], v30 offset:24832
  ds_read_b64_tr_b16 v[84:85], v31 offset:24832
  ds_read_b64_tr_b16 v[86:87], v32 offset:24832
  ds_read_b64_tr_b16 v[88:89], v33 offset:24832
  ds_read_b64_tr_b16 v[90:91], v34 offset:24832
  ds_read_b64_tr_b16 v[92:93], v35 offset:24832
  ds_read_b64_tr_b16 v[94:95], v36 offset:24832
  s_waitcnt lgkmcnt(0)
  s_add_u32 s69, s70, 458752
  s_add_u32 m0, s72, 24576
  s_nop 0
  buffer_load_dwordx4 v10, s[32:35], s69 offen offset:0 nt lds
  buffer_load_dwordx4 v11, s[32:35], s69 offen offset:1024 nt lds
  buffer_load_dwordx4 v12, s[32:35], s69 offen offset:2048 nt lds
  buffer_load_dwordx4 v13, s[32:35], s69 offen offset:3072 nt lds
  s_add_u32 m0, s72, 28672
  s_nop 0
  buffer_load_dwordx4 v14, s[32:35], s69 offen offset:0 nt lds
  buffer_load_dwordx4 v15, s[32:35], s69 offen offset:1024 nt lds
  buffer_load_dwordx4 v16, s[32:35], s69 offen offset:2048 nt lds
  buffer_load_dwordx4 v17, s[32:35], s69 offen offset:3072 nt lds
  v_mfma_f32_16x16x16_bf16 a[0:3], v[64:65], v[134:135], a[0:3]
  v_mfma_f32_16x16x16_bf16 a[4:7], v[66:67], v[134:135], a[4:7]
  v_mfma_f32_16x16x16_bf16 a[8:11], v[68:69], v[134:135], a[8:11]
  v_mfma_f32_16x16x16_bf16 a[12:15], v[70:71], v[134:135], a[12:15]
  v_mfma_f32_16x16x16_bf16 a[16:19], v[72:73], v[134:135], a[16:19]
  v_mfma_f32_16x16x16_bf16 a[20:23], v[74:75], v[134:135], a[20:23]
  v_mfma_f32_16x16x16_bf16 a[24:27], v[76:77], v[134:135], a[24:27]
  v_mfma_f32_16x16x16_bf16 a[28:31], v[78:79], v[134:135], a[28:31]
  v_mfma_f32_16x16x16_bf16 a[32:35], v[80:81], v[134:135], a[32:35]
  v_mfma_f32_16x16x16_bf16 a[36:39], v[82:83], v[134:135], a[36:39]
  v_mfma_f32_16x16x16_bf16 a[40:43], v[84:85], v[134:135], a[40:43]
  v_mfma_f32_16x16x16_bf16 a[44:47], v[86:87], v[134:135], a[44:47]
  v_mfma_f32_16x16x16_bf16 a[48:51], v[88:89], v[134:135], a[48:51]
  v_mfma_f32_16x16x16_bf16 a[52:55], v[90:91], v[134:135], a[52:55]
  v_mfma_f32_16x16x16_bf16 a[56:59], v[92:93], v[134:135], a[56:59]
  v_mfma_f32_16x16x16_bf16 a[60:63], v[94:95], v[134:135], a[60:63]
  s_waitcnt vmcnt(24)
  ds_read_b64_tr_b16 v[64:65], v29 offset:0
  ds_read_b64_tr_b16 v[66:67], v30 offset:0
  ds_read_b64_tr_b16 v[68:69], v31 offset:0
  ds_read_b64_tr_b16 v[70:71], v32 offset:0
  ds_read_b64_tr_b16 v[72:73], v33 offset:0
  ds_read_b64_tr_b16 v[74:75], v34 offset:0
  ds_read_b64_tr_b16 v[76:77], v35 offset:0
  ds_read_b64_tr_b16 v[78:79], v36 offset:0
  ds_read_b64_tr_b16 v[80:81], v29 offset:256
  ds_read_b64_tr_b16 v[82:83], v30 offset:256
  ds_read_b64_tr_b16 v[84:85], v31 offset:256
  ds_read_b64_tr_b16 v[86:87], v32 offset:256
  ds_read_b64_tr_b16 v[88:89], v33 offset:256
  ds_read_b64_tr_b16 v[90:91], v34 offset:256
  ds_read_b64_tr_b16 v[92:93], v35 offset:256
  ds_read_b64_tr_b16 v[94:95], v36 offset:256
  s_waitcnt lgkmcnt(0)
  s_add_u32 s69, s70, 524288
  s_add_u32 m0, s72, 0
  s_nop 0
  buffer_load_dwordx4 v10, s[32:35], s69 offen offset:0 nt lds
  buffer_load_dwordx4 v11, s[32:35], s69 offen offset:1024 nt lds
  buffer_load_dwordx4 v12, s[32:35], s69 offen offset:2048 nt lds
  buffer_load_dwordx4 v13, s[32:35], s69 offen offset:3072 nt lds
  s_add_u32 m0, s72, 4096
  s_nop 0
  buffer_load_dwordx4 v14, s[32:35], s69 offen offset:0 nt lds
  buffer_load_dwordx4 v15, s[32:35], s69 offen offset:1024 nt lds
  buffer_load_dwordx4 v16, s[32:35], s69 offen offset:2048 nt lds
  buffer_load_dwordx4 v17, s[32:35], s69 offen offset:3072 nt lds
  v_mfma_f32_16x16x16_bf16 a[0:3], v[64:65], v[136:137], a[0:3]
  v_mfma_f32_16x16x16_bf16 a[4:7], v[66:67], v[136:137], a[4:7]
  v_mfma_f32_16x16x16_bf16 a[8:11], v[68:69], v[136:137], a[8:11]
  v_mfma_f32_16x16x16_bf16 a[12:15], v[70:71], v[136:137], a[12:15]
  v_mfma_f32_16x16x16_bf16 a[16:19], v[72:73], v[136:137], a[16:19]
  v_mfma_f32_16x16x16_bf16 a[20:23], v[74:75], v[136:137], a[20:23]
  v_mfma_f32_16x16x16_bf16 a[24:27], v[76:77], v[136:137], a[24:27]
  v_mfma_f32_16x16x16_bf16 a[28:31], v[78:79], v[136:137], a[28:31]
  v_mfma_f32_16x16x16_bf16 a[32:35], v[80:81], v[136:137], a[32:35]
  v_mfma_f32_16x16x16_bf16 a[36:39], v[82:83], v[136:137], a[36:39]
  v_mfma_f32_16x16x16_bf16 a[40:43], v[84:85], v[136:137], a[40:43]
  v_mfma_f32_16x16x16_bf16 a[44:47], v[86:87], v[136:137], a[44:47]
  v_mfma_f32_16x16x16_bf16 a[48:51], v[88:89], v[136:137], a[48:51]
  v_mfma_f32_16x16x16_bf16 a[52:55], v[90:91], v[136:137], a[52:55]
  v_mfma_f32_16x16x16_bf16 a[56:59], v[92:93], v[136:137], a[56:59]
  v_mfma_f32_16x16x16_bf16 a[60:63], v[94:95], v[136:137], a[60:63]
  s_waitcnt vmcnt(24)
  ds_read_b64_tr_b16 v[64:65], v29 offset:8192
  ds_read_b64_tr_b16 v[66:67], v30 offset:8192
  ds_read_b64_tr_b16 v[68:69], v31 offset:8192
  ds_read_b64_tr_b16 v[70:71], v32 offset:8192
  ds_read_b64_tr_b16 v[72:73], v33 offset:8192
  ds_read_b64_tr_b16 v[74:75], v34 offset:8192
  ds_read_b64_tr_b16 v[76:77], v35 offset:8192
  ds_read_b64_tr_b16 v[78:79], v36 offset:8192
  ds_read_b64_tr_b16 v[80:81], v29 offset:8448
  ds_read_b64_tr_b16 v[82:83], v30 offset:8448
  ds_read_b64_tr_b16 v[84:85], v31 offset:8448
  ds_read_b64_tr_b16 v[86:87], v32 offset:8448
  ds_read_b64_tr_b16 v[88:89], v33 offset:8448
  ds_read_b64_tr_b16 v[90:91], v34 offset:8448
  ds_read_b64_tr_b16 v[92:93], v35 offset:8448
  ds_read_b64_tr_b16 v[94:95], v36 offset:8448
  s_waitcnt lgkmcnt(0)
  s_add_u32 s69, s70, 589824
  s_add_u32 m0, s72, 8192
  s_nop 0
  buffer_load_dwordx4 v10, s[32:35], s69 offen offset:0 nt lds
  buffer_load_dwordx4 v11, s[32:35], s69 offen offset:1024 nt lds
  buffer_load_dwordx4 v12, s[32:35], s69 offen offset:2048 nt lds
  buffer_load_dwordx4 v13, s[32:35], s69 offen offset:3072 nt lds
  s_add_u32 m0, s72, 12288
  s_nop 0
  buffer_load_dwordx4 v14, s[32:35], s69 offen offset:0 nt lds
  buffer_load_dwordx4 v15, s[32:35], s69 offen offset:1024 nt lds
  buffer_load_dwordx4 v16, s[32:35], s69 offen offset:2048 nt lds
  buffer_load_dwordx4 v17, s[32:35], s69 offen offset:3072 nt lds
  v_mfma_f32_16x16x16_bf16 a[0:3], v[64:65], v[138:139], a[0:3]
  v_mfma_f32_16x16x16_bf16 a[4:7], v[66:67], v[138:139], a[4:7]
  v_mfma_f32_16x16x16_bf16 a[8:11], v[68:69], v[138:139], a[8:11]
  v_mfma_f32_16x16x16_bf16 a[12:15], v[70:71], v[138:139], a[12:15]
  v_mfma_f32_16x16x16_bf16 a[16:19], v[72:73], v[138:139], a[16:19]
  v_mfma_f32_16x16x16_bf16 a[20:23], v[74:75], v[138:139], a[20:23]
  v_mfma_f32_16x16x16_bf16 a[24:27], v[76:77], v[138:139], a[24:27]
  v_mfma_f32_16x16x16_bf16 a[28:31], v[78:79], v[138:139], a[28:31]
  v_mfma_f32_16x16x16_bf16 a[32:35], v[80:81], v[138:139], a[32:35]
  v_mfma_f32_16x16x16_bf16 a[36:39], v[82:83], v[138:139], a[36:39]
  v_mfma_f32_16x16x16_bf16 a[40:43], v[84:85], v[138:139], a[40:43]
  v_mfma_f32_16x16x16_bf16 a[44:47], v[86:87], v[138:139], a[44:47]
  v_mfma_f32_16x16x16_bf16 a[48:51], v[88:89], v[138:139], a[48:51]
  v_mfma_f32_16x16x16_bf16 a[52:55], v[90:91], v[138:139], a[52:55]
  v_mfma_f32_16x16x16_bf16 a[56:59], v[92:93], v[138:139], a[56:59]
  v_mfma_f32_16x16x16_bf16 a[60:63], v[94:95], v[138:139], a[60:63]
  s_waitcnt vmcnt(24)
  ds_read_b64_tr_b16 v[64:65], v29 offset:16384
  ds_read_b64_tr_b16 v[66:67], v30 offset:16384
  ds_read_b64_tr_b16 v[68:69], v31 offset:16384
  ds_read_b64_tr_b16 v[70:71], v32 offset:16384
  ds_read_b64_tr_b16 v[72:73], v33 offset:16384
  ds_read_b64_tr_b16 v[74:75], v34 offset:16384
  ds_read_b64_tr_b16 v[76:77], v35 offset:16384
  ds_read_b64_tr_b16 v[78:79], v36 offset:16384
  ds_read_b64_tr_b16 v[80:81], v29 offset:16640
  ds_read_b64_tr_b16 v[82:83], v30 offset:16640
  ds_read_b64_tr_b16 v[84:85], v31 offset:16640
  ds_read_b64_tr_b16 v[86:87], v32 offset:16640
  ds_read_b64_tr_b16 v[88:89], v33 offset:16640
  ds_read_b64_tr_b16 v[90:91], v34 offset:16640
  ds_read_b64_tr_b16 v[92:93], v35 offset:16640
  ds_read_b64_tr_b16 v[94:95], v36 offset:16640
  s_waitcnt lgkmcnt(0)
  s_add_u32 s69, s70, 655360
  s_add_u32 m0, s72, 16384
  s_nop 0
  buffer_load_dwordx4 v10, s[32:35], s69 offen offset:0 nt lds
  buffer_load_dwordx4 v11, s[32:35], s69 offen offset:1024 nt lds
  buffer_load_dwordx4 v12, s[32:35], s69 offen offset:2048 nt lds
  buffer_load_dwordx4 v13, s[32:35], s69 offen offset:3072 nt lds
  s_add_u32 m0, s72, 20480
  s_nop 0
  buffer_load_dwordx4 v14, s[32:35], s69 offen offset:0 nt lds
  buffer_load_dwordx4 v15, s[32:35], s69 offen offset:1024 nt lds
  buffer_load_dwordx4 v16, s[32:35], s69 offen offset:2048 nt lds
  buffer_load_dwordx4 v17, s[32:35], s69 offen offset:3072 nt lds
  v_mfma_f32_16x16x16_bf16 a[0:3], v[64:65], v[140:141], a[0:3]
  v_mfma_f32_16x16x16_bf16 a[4:7], v[66:67], v[140:141], a[4:7]
  v_mfma_f32_16x16x16_bf16 a[8:11], v[68:69], v[140:141], a[8:11]
  v_mfma_f32_16x16x16_bf16 a[12:15], v[70:71], v[140:141], a[12:15]
  v_mfma_f32_16x16x16_bf16 a[16:19], v[72:73], v[140:141], a[16:19]
  v_mfma_f32_16x16x16_bf16 a[20:23], v[74:75], v[140:141], a[20:23]
  v_mfma_f32_16x16x16_bf16 a[24:27], v[76:77], v[140:141], a[24:27]
  v_mfma_f32_16x16x16_bf16 a[28:31], v[78:79], v[140:141], a[28:31]
  v_mfma_f32_16x16x16_bf16 a[32:35], v[80:81], v[140:141], a[32:35]
  v_mfma_f32_16x16x16_bf16 a[36:39], v[82:83], v[140:141], a[36:39]
  v_mfma_f32_16x16x16_bf16 a[40:43], v[84:85], v[140:141], a[40:43]
  v_mfma_f32_16x16x16_bf16 a[44:47], v[86:87], v[140:141], a[44:47]
  v_mfma_f32_16x16x16_bf16 a[48:51], v[88:89], v[140:141], a[48:51]
  v_mfma_f32_16x16x16_bf16 a[52:55], v[90:91], v[140:141], a[52:55]
  v_mfma_f32_16x16x16_bf16 a[56:59], v[92:93], v[140:141], a[56:59]
  v_mfma_f32_16x16x16_bf16 a[60:63], v[94:95], v[140:141], a[60:63]
  s_waitcnt vmcnt(24)
  ds_read_b64_tr_b16 v[64:65], v29 offset:24576
  ds_read_b64_tr_b16 v[66:67], v30 offset:24576
  ds_read_b64_tr_b16 v[68:69], v31 offset:24576
  ds_read_b64_tr_b16 v[70:71], v32 offset:24576
  ds_read_b64_tr_b16 v[72:73], v33 offset:24576
  ds_read_b64_tr_b16 v[74:75], v34 offset:24576
  ds_read_b64_tr_b16 v[76:77], v35 offset:24576
  ds_read_b64_tr_b16 v[78:79], v36 offset:24576
  ds_read_b64_tr_b16 v[80:81], v29 offset:24832
  ds_read_b64_tr_b16 v[82:83], v30 offset:24832
  ds_read_b64_tr_b16 v[84:85], v31 offset:24832
  ds_read_b64_tr_b16 v[86:87], v32 offset:24832
  ds_read_b64_tr_b16 v[88:89], v33 offset:24832
  ds_read_b64_tr_b16 v[90:91], v34 offset:24832
  ds_read_b64_tr_b16 v[92:93], v35 offset:24832
  ds_read_b64_tr_b16 v[94:95], v36 offset:24832
  s_waitcnt lgkmcnt(0)
  s_add_u32 s69, s70, 720896
  s_add_u32 m0, s72, 24576
  s_nop 0
  buffer_load_dwordx4 v10, s[32:35], s69 offen offset:0 nt lds
  buffer_load_dwordx4 v11, s[32:35], s69 offen offset:1024 nt lds
  buffer_load_dwordx4 v12, s[32:35], s69 offen offset:2048 nt lds
  buffer_load_dwordx4 v13, s[32:35], s69 offen offset:3072 nt lds
  s_add_u32 m0, s72, 28672
  s_nop 0
  buffer_load_dwordx4 v14, s[32:35], s69 offen offset:0 nt lds
  buffer_load_dwordx4 v15, s[32:35], s69 offen offset:1024 nt lds
  buffer_load_dwordx4 v16, s[32:35], s69 offen offset:2048 nt lds
  buffer_load_dwordx4 v17, s[32:35], s69 offen offset:3072 nt lds
  v_mfma_f32_16x16x16_bf16 a[0:3], v[64:65], v[142:143], a[0:3]
  v_mfma_f32_16x16x16_bf16 a[4:7], v[66:67], v[142:143], a[4:7]
  v_mfma_f32_16x16x16_bf16 a[8:11], v[68:69], v[142:143], a[8:11]
  v_mfma_f32_16x16x16_bf16 a[12:15], v[70:71], v[142:143], a[12:15]
  v_mfma_f32_16x16x16_bf16 a[16:19], v[72:73], v[142:143], a[16:19]
  v_mfma_f32_16x16x16_bf16 a[20:23], v[74:75], v[142:143], a[20:23]
  v_mfma_f32_16x16x16_bf16 a[24:27], v[76:77], v[142:143], a[24:27]
  v_mfma_f32_16x16x16_bf16 a[28:31], v[78:79], v[142:143], a[28:31]
  v_mfma_f32_16x16x16_bf16 a[32:35], v[80:81], v[142:143], a[32:35]
  v_mfma_f32_16x16x16_bf16 a[36:39], v[82:83], v[142:143], a[36:39]
  v_mfma_f32_16x16x16_bf16 a[40:43], v[84:85], v[142:143], a[40:43]
  v_mfma_f32_16x16x16_bf16 a[44:47], v[86:87], v[142:143], a[44:47]
  v_mfma_f32_16x16x16_bf16 a[48:51], v[88:89], v[142:143], a[48:51]
  v_mfma_f32_16x16x16_bf16 a[52:55], v[90:91], v[142:143], a[52:55]
  v_mfma_f32_16x16x16_bf16 a[56:59], v[92:93], v[142:143], a[56:59]
  v_mfma_f32_16x16x16_bf16 a[60:63], v[94:95], v[142:143], a[60:63]
  s_waitcnt vmcnt(24)
  ds_read_b64_tr_b16 v[64:65], v29 offset:0
  ds_read_b64_tr_b16 v[66:67], v30 offset:0
  ds_read_b64_tr_b16 v[68:69], v31 offset:0
  ds_read_b64_tr_b16 v[70:71], v32 offset:0
  ds_read_b64_tr_b16 v[72:73], v33 offset:0
  ds_read_b64_tr_b16 v[74:75], v34 offset:0
  ds_read_b64_tr_b16 v[76:77], v35 offset:0
  ds_read_b64_tr_b16 v[78:79], v36 offset:0
  ds_read_b64_tr_b16 v[80:81], v29 offset:256
  ds_read_b64_tr_b16 v[82:83], v30 offset:256
  ds_read_b64_tr_b16 v[84:85], v31 offset:256
  ds_read_b64_tr_b16 v[86:87], v32 offset:256
  ds_read_b64_tr_b16 v[88:89], v33 offset:256
  ds_read_b64_tr_b16 v[90:91], v34 offset:256
  ds_read_b64_tr_b16 v[92:93], v35 offset:256
  ds_read_b64_tr_b16 v[94:95], v36 offset:256
  s_waitcnt lgkmcnt(0)
  s_add_u32 s69, s70, 786432
  s_add_u32 m0, s72, 0
  s_nop 0
  buffer_load_dwordx4 v10, s[32:35], s69 offen offset:0 nt lds
  buffer_load_dwordx4 v11, s[32:35], s69 offen offset:1024 nt lds
  buffer_load_dwordx4 v12, s[32:35], s69 offen offset:2048 nt lds
  buffer_load_dwordx4 v13, s[32:35], s69 offen offset:3072 nt lds
  s_add_u32 m0, s72, 4096
  s_nop 0
  buffer_load_dwordx4 v14, s[32:35], s69 offen offset:0 nt lds
  buffer_load_dwordx4 v15, s[32:35], s69 offen offset:1024 nt lds
  buffer_load_dwordx4 v16, s[32:35], s69 offen offset:2048 nt lds
  buffer_load_dwordx4 v17, s[32:35], s69 offen offset:3072 nt lds
  v_mfma_f32_16x16x16_bf16 a[0:3], v[64:65], v[144:145], a[0:3]
  v_mfma_f32_16x16x16_bf16 a[4:7], v[66:67], v[144:145], a[4:7]
  v_mfma_f32_16x16x16_bf16 a[8:11], v[68:69], v[144:145], a[8:11]
  v_mfma_f32_16x16x16_bf16 a[12:15], v[70:71], v[144:145], a[12:15]
  v_mfma_f32_16x16x16_bf16 a[16:19], v[72:73], v[144:145], a[16:19]
  v_mfma_f32_16x16x16_bf16 a[20:23], v[74:75], v[144:145], a[20:23]
  v_mfma_f32_16x16x16_bf16 a[24:27], v[76:77], v[144:145], a[24:27]
  v_mfma_f32_16x16x16_bf16 a[28:31], v[78:79], v[144:145], a[28:31]
  v_mfma_f32_16x16x16_bf16 a[32:35], v[80:81], v[144:145], a[32:35]
  v_mfma_f32_16x16x16_bf16 a[36:39], v[82:83], v[144:145], a[36:39]
  v_mfma_f32_16x16x16_bf16 a[40:43], v[84:85], v[144:145], a[40:43]
  v_mfma_f32_16x16x16_bf16 a[44:47], v[86:87], v[144:145], a[44:47]
  v_mfma_f32_16x16x16_bf16 a[48:51], v[88:89], v[144:145], a[48:51]
  v_mfma_f32_16x16x16_bf16 a[52:55], v[90:91], v[144:145], a[52:55]
  v_mfma_f32_16x16x16_bf16 a[56:59], v[92:93], v[144:145], a[56:59]
  v_mfma_f32_16x16x16_bf16 a[60:63], v[94:95], v[144:145], a[60:63]
  s_waitcnt vmcnt(24)
  ds_read_b64_tr_b16 v[64:65], v29 offset:8192
  ds_read_b64_tr_b16 v[66:67], v30 offset:8192
  ds_read_b64_tr_b16 v[68:69], v31 offset:8192
  ds_read_b64_tr_b16 v[70:71], v32 offset:8192
  ds_read_b64_tr_b16 v[72:73], v33 offset:8192
  ds_read_b64_tr_b16 v[74:75], v34 offset:8192
  ds_read_b64_tr_b16 v[76:77], v35 offset:8192
  ds_read_b64_tr_b16 v[78:79], v36 offset:8192
  ds_read_b64_tr_b16 v[80:81], v29 offset:8448
  ds_read_b64_tr_b16 v[82:83], v30 offset:8448
  ds_read_b64_tr_b16 v[84:85], v31 offset:8448
  ds_read_b64_tr_b16 v[86:87], v32 offset:8448
  ds_read_b64_tr_b16 v[88:89], v33 offset:8448
  ds_read_b64_tr_b16 v[90:91], v34 offset:8448
  ds_read_b64_tr_b16 v[92:93], v35 offset:8448
  ds_read_b64_tr_b16 v[94:95], v36 offset:8448
  s_waitcnt lgkmcnt(0)
  s_add_u32 s69, s70, 851968
  s_add_u32 m0, s72, 8192
  s_nop 0
  buffer_load_dwordx4 v10, s[32:35], s69 offen offset:0 nt lds
  buffer_load_dwordx4 v11, s[32:35], s69 offen offset:1024 nt lds
  buffer_load_dwordx4 v12, s[32:35], s69 offen offset:2048 nt lds
  buffer_load_dwordx4 v13, s[32:35], s69 offen offset:3072 nt lds
  s_add_u32 m0, s72, 12288
  s_nop 0
  buffer_load_dwordx4 v14, s[32:35], s69 offen offset:0 nt lds
  buffer_load_dwordx4 v15, s[32:35], s69 offen offset:1024 nt lds
  buffer_load_dwordx4 v16, s[32:35], s69 offen offset:2048 nt lds
  buffer_load_dwordx4 v17, s[32:35], s69 offen offset:3072 nt lds
  v_mfma_f32_16x16x16_bf16 a[0:3], v[64:65], v[146:147], a[0:3]
  v_mfma_f32_16x16x16_bf16 a[4:7], v[66:67], v[146:147], a[4:7]
  v_mfma_f32_16x16x16_bf16 a[8:11], v[68:69], v[146:147], a[8:11]
  v_mfma_f32_16x16x16_bf16 a[12:15], v[70:71], v[146:147], a[12:15]
  v_mfma_f32_16x16x16_bf16 a[16:19], v[72:73], v[146:147], a[16:19]
  v_mfma_f32_16x16x16_bf16 a[20:23], v[74:75], v[146:147], a[20:23]
  v_mfma_f32_16x16x16_bf16 a[24:27], v[76:77], v[146:147], a[24:27]
  v_mfma_f32_16x16x16_bf16 a[28:31], v[78:79], v[146:147], a[28:31]
  v_mfma_f32_16x16x16_bf16 a[32:35], v[80:81], v[146:147], a[32:35]
  v_mfma_f32_16x16x16_bf16 a[36:39], v[82:83], v[146:147], a[36:39]
  v_mfma_f32_16x16x16_bf16 a[40:43], v[84:85], v[146:147], a[40:43]
  v_mfma_f32_16x16x16_bf16 a[44:47], v[86:87], v[146:147], a[44:47]
  v_mfma_f32_16x16x16_bf16 a[48:51], v[88:89], v[146:147], a[48:51]
  v_mfma_f32_16x16x16_bf16 a[52:55], v[90:91], v[146:147], a[52:55]
  v_mfma_f32_16x16x16_bf16 a[56:59], v[92:93], v[146:147], a[56:59]
  v_mfma_f32_16x16x16_bf16 a[60:63], v[94:95], v[146:147], a[60:63]
  s_waitcnt vmcnt(24)
  ds_read_b64_tr_b16 v[64:65], v29 offset:16384
  ds_read_b64_tr_b16 v[66:67], v30 offset:16384
  ds_read_b64_tr_b16 v[68:69], v31 offset:16384
  ds_read_b64_tr_b16 v[70:71], v32 offset:16384
  ds_read_b64_tr_b16 v[72:73], v33 offset:16384
  ds_read_b64_tr_b16 v[74:75], v34 offset:16384
  ds_read_b64_tr_b16 v[76:77], v35 offset:16384
  ds_read_b64_tr_b16 v[78:79], v36 offset:16384
  ds_read_b64_tr_b16 v[80:81], v29 offset:16640
  ds_read_b64_tr_b16 v[82:83], v30 offset:16640
  ds_read_b64_tr_b16 v[84:85], v31 offset:16640
  ds_read_b64_tr_b16 v[86:87], v32 offset:16640
  ds_read_b64_tr_b16 v[88:89], v33 offset:16640
  ds_read_b64_tr_b16 v[90:91], v34 offset:16640
  ds_read_b64_tr_b16 v[92:93], v35 offset:16640
  ds_read_b64_tr_b16 v[94:95], v36 offset:16640
  s_waitcnt lgkmcnt(0)
  s_add_u32 s69, s70, 917504
  s_add_u32 m0, s72, 16384
  s_nop 0
  buffer_load_dwordx4 v10, s[32:35], s69 offen offset:0 nt lds
  buffer_load_dwordx4 v11, s[32:35], s69 offen offset:1024 nt lds
  buffer_load_dwordx4 v12, s[32:35], s69 offen offset:2048 nt lds
  buffer_load_dwordx4 v13, s[32:35], s69 offen offset:3072 nt lds
  s_add_u32 m0, s72, 20480
  s_nop 0
  buffer_load_dwordx4 v14, s[32:35], s69 offen offset:0 nt lds
  buffer_load_dwordx4 v15, s[32:35], s69 offen offset:1024 nt lds
  buffer_load_dwordx4 v16, s[32:35], s69 offen offset:2048 nt lds
  buffer_load_dwordx4 v17, s[32:35], s69 offen offset:3072 nt lds
  v_mfma_f32_16x16x16_bf16 a[0:3], v[64:65], v[148:149], a[0:3]
  v_mfma_f32_16x16x16_bf16 a[4:7], v[66:67], v[148:149], a[4:7]
  v_mfma_f32_16x16x16_bf16 a[8:11], v[68:69], v[148:149], a[8:11]
  v_mfma_f32_16x16x16_bf16 a[12:15], v[70:71], v[148:149], a[12:15]
  v_mfma_f32_16x16x16_bf16 a[16:19], v[72:73], v[148:149], a[16:19]
  v_mfma_f32_16x16x16_bf16 a[20:23], v[74:75], v[148:149], a[20:23]
  v_mfma_f32_16x16x16_bf16 a[24:27], v[76:77], v[148:149], a[24:27]
  v_mfma_f32_16x16x16_bf16 a[28:31], v[78:79], v[148:149], a[28:31]
  v_mfma_f32_16x16x16_bf16 a[32:35], v[80:81], v[148:149], a[32:35]
  v_mfma_f32_16x16x16_bf16 a[36:39], v[82:83], v[148:149], a[36:39]
  v_mfma_f32_16x16x16_bf16 a[40:43], v[84:85], v[148:149], a[40:43]
  v_mfma_f32_16x16x16_bf16 a[44:47], v[86:87], v[148:149], a[44:47]
  v_mfma_f32_16x16x16_bf16 a[48:51], v[88:89], v[148:149], a[48:51]
  v_mfma_f32_16x16x16_bf16 a[52:55], v[90:91], v[148:149], a[52:55]
  v_mfma_f32_16x16x16_bf16 a[56:59], v[92:93], v[148:149], a[56:59]
  v_mfma_f32_16x16x16_bf16 a[60:63], v[94:95], v[148:149], a[60:63]
  s_waitcnt vmcnt(24)
  ds_read_b64_tr_b16 v[64:65], v29 offset:24576
  ds_read_b64_tr_b16 v[66:67], v30 offset:24576
  ds_read_b64_tr_b16 v[68:69], v31 offset:24576
  ds_read_b64_tr_b16 v[70:71], v32 offset:24576
  ds_read_b64_tr_b16 v[72:73], v33 offset:24576
  ds_read_b64_tr_b16 v[74:75], v34 offset:24576
  ds_read_b64_tr_b16 v[76:77], v35 offset:24576
  ds_read_b64_tr_b16 v[78:79], v36 offset:24576
  ds_read_b64_tr_b16 v[80:81], v29 offset:24832
  ds_read_b64_tr_b16 v[82:83], v30 offset:24832
  ds_read_b64_tr_b16 v[84:85], v31 offset:24832
  ds_read_b64_tr_b16 v[86:87], v32 offset:24832
  ds_read_b64_tr_b16 v[88:89], v33 offset:24832
  ds_read_b64_tr_b16 v[90:91], v34 offset:24832
  ds_read_b64_tr_b16 v[92:93], v35 offset:24832
  ds_read_b64_tr_b16 v[94:95], v36 offset:24832
  s_waitcnt lgkmcnt(0)
  s_add_u32 s69, s70, 983040
  s_add_u32 m0, s72, 24576
  s_nop 0
  buffer_load_dwordx4 v10, s[32:35], s69 offen offset:0 nt lds
  buffer_load_dwordx4 v11, s[32:35], s69 offen offset:1024 nt lds
  buffer_load_dwordx4 v12, s[32:35], s69 offen offset:2048 nt lds
  buffer_load_dwordx4 v13, s[32:35], s69 offen offset:3072 nt lds
  s_add_u32 m0, s72, 28672
  s_nop 0
  buffer_load_dwordx4 v14, s[32:35], s69 offen offset:0 nt lds
  buffer_load_dwordx4 v15, s[32:35], s69 offen offset:1024 nt lds
  buffer_load_dwordx4 v16, s[32:35], s69 offen offset:2048 nt lds
  buffer_load_dwordx4 v17, s[32:35], s69 offen offset:3072 nt lds
  v_mfma_f32_16x16x16_bf16 a[0:3], v[64:65], v[150:151], a[0:3]
  v_mfma_f32_16x16x16_bf16 a[4:7], v[66:67], v[150:151], a[4:7]
  v_mfma_f32_16x16x16_bf16 a[8:11], v[68:69], v[150:151], a[8:11]
  v_mfma_f32_16x16x16_bf16 a[12:15], v[70:71], v[150:151], a[12:15]
  v_mfma_f32_16x16x16_bf16 a[16:19], v[72:73], v[150:151], a[16:19]
  v_mfma_f32_16x16x16_bf16 a[20:23], v[74:75], v[150:151], a[20:23]
  v_mfma_f32_16x16x16_bf16 a[24:27], v[76:77], v[150:151], a[24:27]
  v_mfma_f32_16x16x16_bf16 a[28:31], v[78:79], v[150:151], a[28:31]
  v_mfma_f32_16x16x16_bf16 a[32:35], v[80:81], v[150:151], a[32:35]
  v_mfma_f32_16x16x16_bf16 a[36:39], v[82:83], v[150:151], a[36:39]
  v_mfma_f32_16x16x16_bf16 a[40:43], v[84:85], v[150:151], a[40:43]
  v_mfma_f32_16x16x16_bf16 a[44:47], v[86:87], v[150:151], a[44:47]
  v_mfma_f32_16x16x16_bf16 a[48:51], v[88:89], v[150:151], a[48:51]
  v_mfma_f32_16x16x16_bf16 a[52:55], v[90:91], v[150:151], a[52:55]
  v_mfma_f32_16x16x16_bf16 a[56:59], v[92:93], v[150:151], a[56:59]
  v_mfma_f32_16x16x16_bf16 a[60:63], v[94:95], v[150:151], a[60:63]
  s_waitcnt vmcnt(24)
  ds_read_b64_tr_b16 v[64:65], v29 offset:0
  ds_read_b64_tr_b16 v[66:67], v30 offset:0
  ds_read_b64_tr_b16 v[68:69], v31 offset:0
  ds_read_b64_tr_b16 v[70:71], v32 offset:0
  ds_read_b64_tr_b16 v[72:73], v33 offset:0
  ds_read_b64_tr_b16 v[74:75], v34 offset:0
  ds_read_b64_tr_b16 v[76:77], v35 offset:0
  ds_read_b64_tr_b16 v[78:79], v36 offset:0
  ds_read_b64_tr_b16 v[80:81], v29 offset:256
  ds_read_b64_tr_b16 v[82:83], v30 offset:256
  ds_read_b64_tr_b16 v[84:85], v31 offset:256
  ds_read_b64_tr_b16 v[86:87], v32 offset:256
  ds_read_b64_tr_b16 v[88:89], v33 offset:256
  ds_read_b64_tr_b16 v[90:91], v34 offset:256
  ds_read_b64_tr_b16 v[92:93], v35 offset:256
  ds_read_b64_tr_b16 v[94:95], v36 offset:256
  s_waitcnt lgkmcnt(0)
  v_mfma_f32_16x16x16_bf16 a[0:3], v[64:65], v[152:153], a[0:3]
  v_mfma_f32_16x16x16_bf16 a[4:7], v[66:67], v[152:153], a[4:7]
  v_mfma_f32_16x16x16_bf16 a[8:11], v[68:69], v[152:153], a[8:11]
  v_mfma_f32_16x16x16_bf16 a[12:15], v[70:71], v[152:153], a[12:15]
  v_mfma_f32_16x16x16_bf16 a[16:19], v[72:73], v[152:153], a[16:19]
  v_mfma_f32_16x16x16_bf16 a[20:23], v[74:75], v[152:153], a[20:23]
  v_mfma_f32_16x16x16_bf16 a[24:27], v[76:77], v[152:153], a[24:27]
  v_mfma_f32_16x16x16_bf16 a[28:31], v[78:79], v[152:153], a[28:31]
  v_mfma_f32_16x16x16_bf16 a[32:35], v[80:81], v[152:153], a[32:35]
  v_mfma_f32_16x16x16_bf16 a[36:39], v[82:83], v[152:153], a[36:39]
  v_mfma_f32_16x16x16_bf16 a[40:43], v[84:85], v[152:153], a[40:43]
  v_mfma_f32_16x16x16_bf16 a[44:47], v[86:87], v[152:153], a[44:47]
  v_mfma_f32_16x16x16_bf16 a[48:51], v[88:89], v[152:153], a[48:51]
  v_mfma_f32_16x16x16_bf16 a[52:55], v[90:91], v[152:153], a[52:55]
  v_mfma_f32_16x16x16_bf16 a[56:59], v[92:93], v[152:153], a[56:59]
  v_mfma_f32_16x16x16_bf16 a[60:63], v[94:95], v[152:153], a[60:63]
  s_waitcnt vmcnt(16)
  ds_read_b64_tr_b16 v[64:65], v29 offset:8192
  ds_read_b64_tr_b16 v[66:67], v30 offset:8192
  ds_read_b64_tr_b16 v[68:69], v31 offset:8192
  ds_read_b64_tr_b16 v[70:71], v32 offset:8192
  ds_read_b64_tr_b16 v[72:73], v33 offset:8192
  ds_read_b64_tr_b16 v[74:75], v34 offset:8192
  ds_read_b64_tr_b16 v[76:77], v35 offset:8192
  ds_read_b64_tr_b16 v[78:79], v36 offset:8192
  ds_read_b64_tr_b16 v[80:81], v29 offset:8448
  ds_read_b64_tr_b16 v[82:83], v30 offset:8448
  ds_read_b64_tr_b16 v[84:85], v31 offset:8448
  ds_read_b64_tr_b16 v[86:87], v32 offset:8448
  ds_read_b64_tr_b16 v[88:89], v33 offset:8448
  ds_read_b64_tr_b16 v[90:91], v34 offset:8448
  ds_read_b64_tr_b16 v[92:93], v35 offset:8448
  ds_read_b64_tr_b16 v[94:95], v36 offset:8448
  s_waitcnt lgkmcnt(0)
  v_mfma_f32_16x16x16_bf16 a[0:3], v[64:65], v[154:155], a[0:3]
  v_mfma_f32_16x16x16_bf16 a[4:7], v[66:67], v[154:155], a[4:7]
  v_mfma_f32_16x16x16_bf16 a[8:11], v[68:69], v[154:155], a[8:11]
  v_mfma_f32_16x16x16_bf16 a[12:15], v[70:71], v[154:155], a[12:15]
  v_mfma_f32_16x16x16_bf16 a[16:19], v[72:73], v[154:155], a[16:19]
  v_mfma_f32_16x16x16_bf16 a[20:23], v[74:75], v[154:155], a[20:23]
  v_mfma_f32_16x16x16_bf16 a[24:27], v[76:77], v[154:155], a[24:27]
  v_mfma_f32_16x16x16_bf16 a[28:31], v[78:79], v[154:155], a[28:31]
  v_mfma_f32_16x16x16_bf16 a[32:35], v[80:81], v[154:155], a[32:35]
  v_mfma_f32_16x16x16_bf16 a[36:39], v[82:83], v[154:155], a[36:39]
  v_mfma_f32_16x16x16_bf16 a[40:43], v[84:85], v[154:155], a[40:43]
  v_mfma_f32_16x16x16_bf16 a[44:47], v[86:87], v[154:155], a[44:47]
  v_mfma_f32_16x16x16_bf16 a[48:51], v[88:89], v[154:155], a[48:51]
  v_mfma_f32_16x16x16_bf16 a[52:55], v[90:91], v[154:155], a[52:55]
  v_mfma_f32_16x16x16_bf16 a[56:59], v[92:93], v[154:155], a[56:59]
  v_mfma_f32_16x16x16_bf16 a[60:63], v[94:95], v[154:155], a[60:63]
  s_waitcnt vmcnt(8)
  ds_read_b64_tr_b16 v[64:65], v29 offset:16384
  ds_read_b64_tr_b16 v[66:67], v30 offset:16384
  ds_read_b64_tr_b16 v[68:69], v31 offset:16384
  ds_read_b64_tr_b16 v[70:71], v32 offset:16384
  ds_read_b64_tr_b16 v[72:73], v33 offset:16384
  ds_read_b64_tr_b16 v[74:75], v34 offset:16384
  ds_read_b64_tr_b16 v[76:77], v35 offset:16384
  ds_read_b64_tr_b16 v[78:79], v36 offset:16384
  ds_read_b64_tr_b16 v[80:81], v29 offset:16640
  ds_read_b64_tr_b16 v[82:83], v30 offset:16640
  ds_read_b64_tr_b16 v[84:85], v31 offset:16640
  ds_read_b64_tr_b16 v[86:87], v32 offset:16640
  ds_read_b64_tr_b16 v[88:89], v33 offset:16640
  ds_read_b64_tr_b16 v[90:91], v34 offset:16640
  ds_read_b64_tr_b16 v[92:93], v35 offset:16640
  ds_read_b64_tr_b16 v[94:95], v36 offset:16640
  s_waitcnt lgkmcnt(0)
  v_mfma_f32_16x16x16_bf16 a[0:3], v[64:65], v[156:157], a[0:3]
  v_mfma_f32_16x16x16_bf16 a[4:7], v[66:67], v[156:157], a[4:7]
  v_mfma_f32_16x16x16_bf16 a[8:11], v[68:69], v[156:157], a[8:11]
  v_mfma_f32_16x16x16_bf16 a[12:15], v[70:71], v[156:157], a[12:15]
  v_mfma_f32_16x16x16_bf16 a[16:19], v[72:73], v[156:157], a[16:19]
  v_mfma_f32_16x16x16_bf16 a[20:23], v[74:75], v[156:157], a[20:23]
  v_mfma_f32_16x16x16_bf16 a[24:27], v[76:77], v[156:157], a[24:27]
  v_mfma_f32_16x16x16_bf16 a[28:31], v[78:79], v[156:157], a[28:31]
  v_mfma_f32_16x16x16_bf16 a[32:35], v[80:81], v[156:157], a[32:35]
  v_mfma_f32_16x16x16_bf16 a[36:39], v[82:83], v[156:157], a[36:39]
  v_mfma_f32_16x16x16_bf16 a[40:43], v[84:85], v[156:157], a[40:43]
  v_mfma_f32_16x16x16_bf16 a[44:47], v[86:87], v[156:157], a[44:47]
  v_mfma_f32_16x16x16_bf16 a[48:51], v[88:89], v[156:157], a[48:51]
  v_mfma_f32_16x16x16_bf16 a[52:55], v[90:91], v[156:157], a[52:55]
  v_mfma_f32_16x16x16_bf16 a[56:59], v[92:93], v[156:157], a[56:59]
  v_mfma_f32_16x16x16_bf16 a[60:63], v[94:95], v[156:157], a[60:63]
  s_waitcnt vmcnt(0)
  ds_read_b64_tr_b16 v[64:65], v29 offset:24576
  ds_read_b64_tr_b16 v[66:67], v30 offset:24576
  ds_read_b64_tr_b16 v[68:69], v31 offset:24576
  ds_read_b64_tr_b16 v[70:71], v32 offset:24576
  ds_read_b64_tr_b16 v[72:73], v33 offset:24576
  ds_read_b64_tr_b16 v[74:75], v34 offset:24576
  ds_read_b64_tr_b16 v[76:77], v35 offset:24576
  ds_read_b64_tr_b16 v[78:79], v36 offset:24576
  ds_read_b64_tr_b16 v[80:81], v29 offset:24832
  ds_read_b64_tr_b16 v[82:83], v30 offset:24832
  ds_read_b64_tr_b16 v[84:85], v31 offset:24832
  ds_read_b64_tr_b16 v[86:87], v32 offset:24832
  ds_read_b64_tr_b16 v[88:89], v33 offset:24832
  ds_read_b64_tr_b16 v[90:91], v34 offset:24832
  ds_read_b64_tr_b16 v[92:93], v35 offset:24832
  ds_read_b64_tr_b16 v[94:95], v36 offset:24832
  s_waitcnt lgkmcnt(0)
  v_mfma_f32_16x16x16_bf16 a[0:3], v[64:65], v[158:159], a[0:3]
  v_mfma_f32_16x16x16_bf16 a[4:7], v[66:67], v[158:159], a[4:7]
  v_mfma_f32_16x16x16_bf16 a[8:11], v[68:69], v[158:159], a[8:11]
  v_mfma_f32_16x16x16_bf16 a[12:15], v[70:71], v[158:159], a[12:15]
  v_mfma_f32_16x16x16_bf16 a[16:19], v[72:73], v[158:159], a[16:19]
  v_mfma_f32_16x16x16_bf16 a[20:23], v[74:75], v[158:159], a[20:23]
  v_mfma_f32_16x16x16_bf16 a[24:27], v[76:77], v[158:159], a[24:27]
  v_mfma_f32_16x16x16_bf16 a[28:31], v[78:79], v[158:159], a[28:31]
  v_mfma_f32_16x16x16_bf16 a[32:35], v[80:81], v[158:159], a[32:35]
  v_mfma_f32_16x16x16_bf16 a[36:39], v[82:83], v[158:159], a[36:39]
  v_mfma_f32_16x16x16_bf16 a[40:43], v[84:85], v[158:159], a[40:43]
  v_mfma_f32_16x16x16_bf16 a[44:47], v[86:87], v[158:159], a[44:47]
  v_mfma_f32_16x16x16_bf16 a[48:51], v[88:89], v[158:159], a[48:51]
  v_mfma_f32_16x16x16_bf16 a[52:55], v[90:91], v[158:159], a[52:55]
  v_mfma_f32_16x16x16_bf16 a[56:59], v[92:93], v[158:159], a[56:59]
  v_mfma_f32_16x16x16_bf16 a[60:63], v[94:95], v[158:159], a[60:63]
  v_lshrrev_b32 v200, 2, v1
  v_and_b32 v201, 3, v1
  v_mul_u32_u24 v200, 14336, v200
  v_lshl_add_u32 v200, v201, 4, v200
  v_mov_b32 v202, 0x10000000
  s_cmp_lt_u32 s74, 28
  s_cselect_b32 s98, s3, 0
  s_cmp_eq_u32 s98, 1
  s_cselect_b64 vcc, -1, 0
  v_cndmask_b32 v193, v202, v200, vcc
  s_mul_i32 s100, s10, 1792
  s_lshl_b32 s98, s74, 6
  s_add_u32 s100, s100, s98
  s_add_u32 s100, s100, 3145728
  s_mov_b32 s60, s22
  s_and_b32 s61, s23, 0xffff
  s_mov_b32 s62, 7168
  s_mov_b32 s63, 0x20000
  v_lshrrev_b32 v44, 2, v1
  v_and_b32 v45, 3, v1
  v_lshlrev_b32 v47, 5, v37
  s_lshl_b32 s68, s3, 3
  s_add_u32 s68, s68, 162560
  v_add_u32 v47, s68, v47
  v_mov_b32 v61, v62
  v_lshlrev_b32 v46, 10, v37
  v_lshl_add_u32 v46, v38, 4, v46
  v_add_u32 v46, s72, v46
  s_mov_b32 s98, 0x00030003
  s_mov_b32 s99, 0x00030003
  s_mov_b64 exec, s[98:99]
  ds_write_b128 v46, a[0:3] offset:0
  ds_write_b128 v46, a[4:7] offset:64
  ds_write_b128 v46, a[8:11] offset:128
  ds_write_b128 v46, a[12:15] offset:192
  ds_write_b128 v46, a[16:19] offset:256
  ds_write_b128 v46, a[20:23] offset:320
  ds_write_b128 v46, a[24:27] offset:384
  ds_write_b128 v46, a[28:31] offset:448
  ds_write_b128 v46, a[32:35] offset:512
  ds_write_b128 v46, a[36:39] offset:576
  ds_write_b128 v46, a[40:43] offset:640
  ds_write_b128 v46, a[44:47] offset:704
  ds_write_b128 v46, a[48:51] offset:768
  ds_write_b128 v46, a[52:55] offset:832
  ds_write_b128 v46, a[56:59] offset:896
  ds_write_b128 v46, a[60:63] offset:960
  s_mov_b64 exec, 3
  ds_write_b64 v47, v[60:61]
  s_mov_b64 exec, -1
  s_cmp_lt_u32 s74, 28
  s_cselect_b32 s98, s3, 0
  s_cmp_eq_u32 s98, 1
  s_cbranch_scc0 L_y_noissue
  s_add_u32 s98, s100, 0
  buffer_load_dwordx4 v[160:163], v193, s[36:39], s98 offen sc1
  s_add_u32 s98, s100, 229376
  buffer_load_dwordx4 v[164:167], v193, s[36:39], s98 offen sc1
  s_add_u32 s98, s100, 458752
  buffer_load_dwordx4 v[168:171], v193, s[36:39], s98 offen sc1
  s_add_u32 s98, s100, 688128
  buffer_load_dwordx4 v[172:175], v193, s[36:39], s98 offen sc1
  s_add_u32 s98, s100, 917504
  buffer_load_dwordx4 v[176:179], v193, s[36:39], s98 offen sc1
  s_add_u32 s98, s100, 1146880
  buffer_load_dwordx4 v[180:183], v193, s[36:39], s98 offen sc1
  s_add_u32 s98, s100, 1376256
  buffer_load_dwordx4 v[184:187], v193, s[36:39], s98 offen sc1
L_y_noissue:
  s_waitcnt lgkmcnt(0)
  s_barrier
  s_lshr_b32 s68, s3, 1
  s_lshl_b32 s69, s68, 5
  s_add_u32 s69, s69, 162560
  v_mov_b32 v46, s69
  ds_read_b128 v[64:67], v46
  ds_read_b128 v[68:71], v46 offset:16
  s_lshl_b32 s69, s3, 9
  v_and_b32 v47, 31, v1
  v_lshlrev_b32 v48, 4, v47
  v_add_u32 v46, s69, v48
  v_add_u32 v49, 0x10000, v46
  ds_read_b128 v[72:75], v46
  ds_read_b128 v[76:79], v46 offset:32768
  ds_read_b128 v[80:83], v49
  ds_read_b128 v[84:87], v49 offset:32768
  s_mov_b32 s98, 0x3db8aa3b
  v_cmp_le_u32 vcc, 32, v1
  s_lshl_b32 s68, s75, 2
  s_add_u32 s68, s68, s3
  s_lshl_b32 s68, s68, 12
  s_add_u32 s68, s68, 1048576
  s_lshl_b32 s69, s27, 9
  v_add_u32 v48, s69, v48
  s_lshl_b32 s69, s27, 7
  s_add_u32 s69, s69, 2048
  v_and_b32 v49, 7, v1
  v_lshl_add_u32 v49, v49, 4, s69
  v_cndmask_b32 v48, v48, v49, vcc
  s_waitcnt lgkmcnt(4)
  v_max3_f32 v50, v64, v66, v68
  v_max_f32 v50, v50, v70
  v_sub_f32 v52, v64, v50
  v_sub_f32 v53, v66, v50
  v_sub_f32 v54, v68, v50
  v_sub_f32 v55, v70, v50
  v_mul_f32 v52, s98, v52
  v_mul_f32 v53, s98, v53
  v_mul_f32 v54, s98, v54
  v_mul_f32 v55, s98, v55
  v_exp_f32 v52, v52
  v_exp_f32 v53, v53
  v_exp_f32 v54, v54
  v_exp_f32 v55, v55
  s_nop 0
  v_mul_f32 v51, v52, v65
  v_fmac_f32 v51, v53, v67
  v_fmac_f32 v51, v54, v69
  v_fmac_f32 v51, v55, v71
  s_waitcnt lgkmcnt(0)
  v_mul_f32 v56, v52, v72
  v_mul_f32 v57, v52, v73
  v_mul_f32 v58, v52, v74
  v_mul_f32 v59, v52, v75
  v_fmac_f32 v56, v53, v76
  v_fmac_f32 v57, v53, v77
  v_fmac_f32 v58, v53, v78
  v_fmac_f32 v59, v53, v79
  v_fmac_f32 v56, v54, v80
  v_fmac_f32 v57, v54, v81
  v_fmac_f32 v58, v54, v82
  v_fmac_f32 v59, v54, v83
  v_fmac_f32 v56, v55, v84
  v_fmac_f32 v57, v55, v85
  v_fmac_f32 v58, v55, v86
  v_fmac_f32 v59, v55, v87
  v_cndmask_b32 v56, v56, v50, vcc
  v_cndmask_b32 v57, v57, v51, vcc
  v_cndmask_b32 v58, v58, v50, vcc
  v_cndmask_b32 v59, v59, v51, vcc
  v_and_or_b32 v56, v56, s66, v63
  v_and_or_b32 v57, v57, s66, v63
  v_and_or_b32 v58, v58, s66, v63
  v_and_or_b32 v59, v59, s66, v63
  s_mov_b32 s98, -1
  s_mov_b32 s99, 255
  s_mov_b64 exec, s[98:99]
  s_add_u32 s69, s68, 5242880
  buffer_store_dwordx4 v[56:59], v48, s[36:39], s69 offen
  buffer_store_dwordx4 v[56:59], v48, s[36:39], s68 offen sc1
  s_mov_b64 exec, -1
  s_cmp_eq_u32 s3, 0
  s_cbranch_scc1 L_hop1
  s_cmp_lt_u32 s74, 28
  s_cselect_b32 s98, s3, 0
  s_cmp_eq_u32 s98, 1
  s_cbranch_scc0 L_y_done
  s_waitcnt vmcnt(2)
  v_xor_b32 v160, v160, v63
  v_xor_b32 v161, v161, v63
  v_xor_b32 v162, v162, v63
  v_xor_b32 v163, v163, v63
  v_xor_b32 v164, v164, v63
  v_xor_b32 v165, v165, v63
  v_xor_b32 v166, v166, v63
  v_xor_b32 v167, v167, v63
  v_xor_b32 v168, v168, v63
  v_xor_b32 v169, v169, v63
  v_xor_b32 v170, v170, v63
  v_xor_b32 v171, v171, v63
  v_xor_b32 v172, v172, v63
  v_xor_b32 v173, v173, v63
  v_xor_b32 v174, v174, v63
  v_xor_b32 v175, v175, v63
  v_xor_b32 v176, v176, v63
  v_xor_b32 v177, v177, v63
  v_xor_b32 v178, v178, v63
  v_xor_b32 v179, v179, v63
  v_xor_b32 v180, v180, v63
  v_xor_b32 v181, v181, v63
  v_xor_b32 v182, v182, v63
  v_xor_b32 v183, v183, v63
  v_xor_b32 v184, v184, v63
  v_xor_b32 v185, v185, v63
  v_xor_b32 v186, v186, v63
  v_xor_b32 v187, v187, v63
  v_or_b32 v48, v160, v161
  v_or3_b32 v48, v48, v162, v163
  v_or3_b32 v48, v48, v164, v165
  v_or3_b32 v48, v48, v166, v167
  v_or3_b32 v48, v48, v168, v169
  v_or3_b32 v48, v48, v170, v171
  v_or3_b32 v48, v48, v172, v173
  v_or3_b32 v48, v48, v174, v175
  v_or3_b32 v48, v48, v176, v177
  v_or3_b32 v48, v48, v178, v179
  v_or3_b32 v48, v48, v180, v181
  v_or3_b32 v48, v48, v182, v183
  v_or3_b32 v48, v48, v184, v185
  v_or3_b32 v48, v48, v186, v187
  v_and_b32 v48, 0xff, v48
  v_cmp_eq_u32 vcc, 0, v48
  s_nop 1
  s_cmp_eq_u64 vcc, -1
  s_cbranch_scc1 L_y_ok
  s_mov_b32 s69, 200000
L_yp_5:
  s_add_u32 s98, s100, 0
  buffer_load_dwordx4 v[160:163], v193, s[36:39], s98 offen sc1
  s_add_u32 s98, s100, 229376
  buffer_load_dwordx4 v[164:167], v193, s[36:39], s98 offen sc1
  s_add_u32 s98, s100, 458752
  buffer_load_dwordx4 v[168:171], v193, s[36:39], s98 offen sc1
  s_add_u32 s98, s100, 688128
  buffer_load_dwordx4 v[172:175], v193, s[36:39], s98 offen sc1
  s_add_u32 s98, s100, 917504
  buffer_load_dwordx4 v[176:179], v193, s[36:39], s98 offen sc1
  s_add_u32 s98, s100, 1146880
  buffer_load_dwordx4 v[180:183], v193, s[36:39], s98 offen sc1
  s_add_u32 s98, s100, 1376256
  buffer_load_dwordx4 v[184:187], v193, s[36:39], s98 offen sc1
  s_waitcnt vmcnt(0)
  v_xor_b32 v160, v160, v63
  v_xor_b32 v161, v161, v63
  v_xor_b32 v162, v162, v63
  v_xor_b32 v163, v163, v63
  v_xor_b32 v164, v164, v63
  v_xor_b32 v165, v165, v63
  v_xor_b32 v166, v166, v63
  v_xor_b32 v167, v167, v63
  v_xor_b32 v168, v168, v63
  v_xor_b32 v169, v169, v63
  v_xor_b32 v170, v170, v63
  v_xor_b32 v171, v171, v63
  v_xor_b32 v172, v172, v63
  v_xor_b32 v173, v173, v63
  v_xor_b32 v174, v174, v63
  v_xor_b32 v175, v175, v63
  v_xor_b32 v176, v176, v63
  v_xor_b32 v177, v177, v63
  v_xor_b32 v178, v178, v63
  v_xor_b32 v179, v179, v63
  v_xor_b32 v180, v180, v63
  v_xor_b32 v181, v181, v63
  v_xor_b32 v182, v182, v63
  v_xor_b32 v183, v183, v63
  v_xor_b32 v184, v184, v63
  v_xor_b32 v185, v185, v63
  v_xor_b32 v186, v186, v63
  v_xor_b32 v187, v187, v63
  v_or_b32 v48, v160, v161
  v_or3_b32 v48, v48, v162, v163
  v_or3_b32 v48, v48, v164, v165
  v_or3_b32 v48, v48, v166, v167
  v_or3_b32 v48, v48, v168, v169
  v_or3_b32 v48, v48, v170, v171
  v_or3_b32 v48, v48, v172, v173
  v_or3_b32 v48, v48, v174, v175
  v_or3_b32 v48, v48, v176, v177
  v_or3_b32 v48, v48, v178, v179
  v_or3_b32 v48, v48, v180, v181
  v_or3_b32 v48, v48, v182, v183
  v_or3_b32 v48, v48, v184, v185
  v_or3_b32 v48, v48, v186, v187
  v_and_b32 v48, 0xff, v48
  v_cmp_eq_u32 vcc, 0, v48
  s_nop 1
  s_andn2_b64 exec, exec, vcc
  s_cbranch_scc0 L_ypok_6
  s_sub_u32 s69, s69, 1
  s_cmp_eq_u32 s69, 0
  s_cbranch_scc1 L_ypok_6
  s_branch L_yp_5
L_ypok_6:
  s_mov_b64 exec, -1
L_y_ok:
  v_add_f32 v160, v160, v164
  v_add_f32 v161, v161, v165
  v_add_f32 v162, v162, v166
  v_add_f32 v163, v163, v167
  v_add_f32 v160, v160, v168
  v_add_f32 v161, v161, v169
  v_add_f32 v162, v162, v170
  v_add_f32 v163, v163, v171
  v_add_f32 v160, v160, v172
  v_add_f32 v161, v161, v173
  v_add_f32 v162, v162, v174
  v_add_f32 v163, v163, v175
  v_add_f32 v160, v160, v176
  v_add_f32 v161, v161, v177
  v_add_f32 v162, v162, v178
  v_add_f32 v163, v163, v179
  v_add_f32 v160, v160, v180
  v_add_f32 v161, v161, v181
  v_add_f32 v162, v162, v182
  v_add_f32 v163, v163, v183
  v_add_f32 v160, v160, v184
  v_add_f32 v161, v161, v185
  v_add_f32 v162, v162, v186
  v_add_f32 v163, v163, v187
  s_nop 1
  v_add_f32_dpp v160, v160, v160 row_ror:4 row_mask:0xf bank_mask:0xf
  v_add_f32_dpp v161, v161, v161 row_ror:4 row_mask:0xf bank_mask:0xf
  v_add_f32_dpp v162, v162, v162 row_ror:4 row_mask:0xf bank_mask:0xf
  v_add_f32_dpp v163, v163, v163 row_ror:4 row_mask:0xf bank_mask:0xf
  s_nop 1
  v_add_f32_dpp v160, v160, v160 row_ror:8 row_mask:0xf bank_mask:0xf
  v_add_f32_dpp v161, v161, v161 row_ror:8 row_mask:0xf bank_mask:0xf
  v_add_f32_dpp v162, v162, v162 row_ror:8 row_mask:0xf bank_mask:0xf
  v_add_f32_dpp v163, v163, v163 row_ror:8 row_mask:0xf bank_mask:0xf
  v_mov_b32 v52, v160
  v_mov_b32 v53, v161
  v_mov_b32 v54, v162
  v_mov_b32 v55, v163
  s_nop 1
  v_permlane16_swap_b32 v160, v52
  v_permlane16_swap_b32 v161, v53
  v_permlane16_swap_b32 v162, v54
  v_permlane16_swap_b32 v163, v55
  s_nop 1
  v_add_f32 v160, v160, v52
  v_add_f32 v161, v161, v53
  v_add_f32 v162, v162, v54
  v_add_f32 v163, v163, v55
  v_mov_b32 v52, v160
  v_mov_b32 v53, v161
  v_mov_b32 v54, v162
  v_mov_b32 v55, v163
  s_nop 1
  v_permlane32_swap_b32 v160, v52
  v_permlane32_swap_b32 v161, v53
  v_permlane32_swap_b32 v162, v54
  v_permlane32_swap_b32 v163, v55
  s_nop 1
  v_add_f32 v160, v160, v52
  v_add_f32 v161, v161, v53
  v_add_f32 v162, v162, v54
  v_add_f32 v163, v163, v55
  v_cvt_pk_bf16_f32 v168, v160, v161
  v_cvt_pk_bf16_f32 v169, v162, v163
  v_lshlrev_b32 v56, 16, v168
  v_and_b32 v57, 0xffff0000, v168
  v_lshlrev_b32 v58, 16, v169
  v_and_b32 v59, 0xffff0000, v169
  v_mul_f32 v164, 0xbfb8aa3b, v56
  v_mul_f32 v165, 0xbfb8aa3b, v57
  v_mul_f32 v166, 0xbfb8aa3b, v58
  v_mul_f32 v167, 0xbfb8aa3b, v59
  v_exp_f32 v164, v164
  v_exp_f32 v165, v165
  v_exp_f32 v166, v166
  v_exp_f32 v167, v167
  s_nop 0
  v_add_f32 v164, 1.0, v164
  v_add_f32 v165, 1.0, v165
  v_add_f32 v166, 1.0, v166
  v_add_f32 v167, 1.0, v167
  v_rcp_f32 v164, v164
  v_rcp_f32 v165, v165
  v_rcp_f32 v166, v166
  v_rcp_f32 v167, v167
  s_nop 0
  v_mul_f32 v56, v56, v164
  v_mul_f32 v57, v57, v165
  v_mul_f32 v58, v58, v166
  v_mul_f32 v59, v59, v167
  v_cvt_pk_bf16_f32 v168, v56, v57
  v_cvt_pk_bf16_f32 v169, v58, v59
  v_lshlrev_b32 v201, 3, v201
  v_add_u32 v201, 162880, v201
  s_mov_b64 exec, 15
  ds_write_b64 v201, v[168:169]
  s_mov_b64 exec, -1
L_y_done:
  s_branch L_b4
L_hop1:
  s_lshl_b32 s68, s75, 2
  s_add_u32 s68, s68, s27
  s_lshl_b32 s68, s68, 12
  s_add_u32 s101, s68, 1048576
  s_add_u32 s100, s68, 6291456
  s_mov_b32 s68, s101
  v_lshrrev_b32 v46, 5, v1
  v_lshlrev_b32 v47, 9, v46
  v_and_b32 v48, 31, v1
  v_lshl_add_u32 v47, v48, 4, v47
  v_lshlrev_b32 v46, 7, v46
  v_add_u32 v46, 2048, v46
  s_mov_b32 s69, 200000
L_op_7:
  s_and_b32 s98, s69, 15
  s_cmp_eq_u32 s98, 1
  s_cselect_b32 s68, s101, s100
  buffer_load_dwordx4 v[64:67], v47, s[36:39], s68 offen sc1
  buffer_load_dwordx4 v[68:71], v47, s[36:39], s68 offen offset:1024 sc1
  buffer_load_dwordx4 v[72:75], v46, s[36:39], s68 offen sc1
  buffer_load_dwordx4 v[76:79], v46, s[36:39], s68 offen offset:256 sc1
  s_waitcnt vmcnt(0)
  v_xor_b32 v64, v64, v63
  v_xor_b32 v65, v65, v63
  v_xor_b32 v66, v66, v63
  v_xor_b32 v67, v67, v63
  v_xor_b32 v68, v68, v63
  v_xor_b32 v69, v69, v63
  v_xor_b32 v70, v70, v63
  v_xor_b32 v71, v71, v63
  v_xor_b32 v72, v72, v63
  v_xor_b32 v73, v73, v63
  v_xor_b32 v74, v74, v63
  v_xor_b32 v75, v75, v63
  v_xor_b32 v76, v76, v63
  v_xor_b32 v77, v77, v63
  v_xor_b32 v78, v78, v63
  v_xor_b32 v79, v79, v63
  v_or_b32 v50, v64, v65
  v_or3_b32 v50, v50, v66, v67
  v_or3_b32 v50, v50, v68, v69
  v_or3_b32 v50, v50, v70, v71
  v_or3_b32 v50, v50, v72, v73
  v_or3_b32 v50, v50, v74, v75
  v_or3_b32 v50, v50, v76, v77
  v_or3_b32 v50, v50, v78, v79
  v_and_b32 v50, 0xff, v50
  v_cmp_eq_u32 vcc, 0, v50
  s_nop 1
  s_andn2_b64 exec, exec, vcc
  s_cbranch_scc0 L_opok_8
  s_sub_u32 s69, s69, 1
  s_cmp_eq_u32 s69, 0
  s_cbranch_scc1 L_opok_8
  s_branch L_op_7
L_opok_8:
  s_mov_b64 exec, -1
  v_and_b32 v72, s66, v72
  v_and_b32 v76, s66, v76
  s_mov_b32 s98, 0x3db8aa3b
  v_max_f32 v50, v72, v76
  v_mov_b32 v51, v50
  s_nop 1
  v_permlane32_swap_b32 v50, v51
  s_nop 1
  v_max_f32 v50, v50, v51
  v_sub_f32 v52, v72, v50
  v_sub_f32 v53, v76, v50
  v_mul_f32 v52, s98, v52
  v_mul_f32 v53, s98, v53
  v_exp_f32 v52, v52
  v_exp_f32 v53, v53
  s_nop 0
  v_mul_f32 v56, v52, v73
  v_fmac_f32 v56, v53, v77
  v_mul_f32 v57, v52, v64
  v_mul_f32 v58, v52, v65
  v_mul_f32 v59, v52, v66
  v_mul_f32 v60, v52, v67
  v_fmac_f32 v57, v53, v68
  v_fmac_f32 v58, v53, v69
  v_fmac_f32 v59, v53, v70
  v_fmac_f32 v60, v53, v71
  v_mov_b32 v80, v56
  v_mov_b32 v81, v57
  v_mov_b32 v82, v58
  v_mov_b32 v83, v59
  v_mov_b32 v84, v60
  s_nop 1
  v_permlane32_swap_b32 v56, v80
  v_permlane32_swap_b32 v57, v81
  v_permlane32_swap_b32 v58, v82
  v_permlane32_swap_b32 v59, v83
  v_permlane32_swap_b32 v60, v84
  s_nop 1
  v_add_f32 v56, v56, v80
  v_add_f32 v57, v57, v81
  v_add_f32 v58, v58, v82
  v_add_f32 v59, v59, v83
  v_add_f32 v60, v60, v84
  v_rcp_f32 v56, v56
  s_nop 0
  v_mul_f32 v57, v57, v56
  v_mul_f32 v58, v58, v56
  v_mul_f32 v59, v59, v56
  v_mul_f32 v60, v60, v56
  v_cvt_pk_bf16_f32 v56, v57, v58
  v_cvt_pk_bf16_f32 v57, v59, v60
  v_lshlrev_b32 v48, 3, v48
  v_add_u32 v48, 162624, v48
  s_mov_b32 s98, -1
  s_mov_b32 s99, 0
  s_mov_b64 exec, s[98:99]
  ds_write_b64 v48, v[56:57]
  s_mov_b64 exec, -1
L_b4:
  s_waitcnt lgkmcnt(0)
  s_barrier
  v_lshlrev_b32 v46, 4, v38
  v_add_u32 v46, 162624, v46
  ds_read_b128 v[64:67], v46 offset:0
  ds_read_b128 v[68:71], v46 offset:64
  ds_read_b128 v[72:75], v46 offset:128
  ds_read_b128 v[76:79], v46 offset:192
  v_lshlrev_b32 v47, 4, v38
  v_lshl_add_u32 v47, v37, 6, v47
  s_lshl_b32 s68, s10, 16
  s_lshl_b32 s69, s74, 11
  s_add_u32 s68, s68, s69
  s_mul_i32 s69, s3, 448
  s_add_u32 s68, s68, s69
  s_add_u32 s68, s68, 2097152
  s_waitcnt lgkmcnt(0)
  v_mfma_f32_16x16x32_bf16 v[96:99], a[64:67], v[64:67], 0
  v_mfma_f32_16x16x32_bf16 v[100:103], a[80:83], v[64:67], 0
  v_mfma_f32_16x16x32_bf16 v[104:107], a[96:99], v[64:67], 0
  v_mfma_f32_16x16x32_bf16 v[108:111], a[112:115], v[64:67], 0
  v_mfma_f32_16x16x32_bf16 v[112:115], a[128:131], v[64:67], 0
  v_mfma_f32_16x16x32_bf16 v[116:119], a[144:147], v[64:67], 0
  v_mfma_f32_16x16x32_bf16 v[120:123], a[160:163], v[64:67], 0
  v_mfma_f32_16x16x32_bf16 v[96:99], a[68:71], v[68:71], v[96:99]
  v_mfma_f32_16x16x32_bf16 v[100:103], a[84:87], v[68:71], v[100:103]
  v_mfma_f32_16x16x32_bf16 v[104:107], a[100:103], v[68:71], v[104:107]
  v_mfma_f32_16x16x32_bf16 v[108:111], a[116:119], v[68:71], v[108:111]
  v_mfma_f32_16x16x32_bf16 v[112:115], a[132:135], v[68:71], v[112:115]
  v_mfma_f32_16x16x32_bf16 v[116:119], a[148:151], v[68:71], v[116:119]
  v_mfma_f32_16x16x32_bf16 v[120:123], a[164:167], v[68:71], v[120:123]
  v_mfma_f32_16x16x32_bf16 v[96:99], a[72:75], v[72:75], v[96:99]
  v_mfma_f32_16x16x32_bf16 v[100:103], a[88:91], v[72:75], v[100:103]
  v_mfma_f32_16x16x32_bf16 v[104:107], a[104:107], v[72:75], v[104:107]
  v_mfma_f32_16x16x32_bf16 v[108:111], a[120:123], v[72:75], v[108:111]
  v_mfma_f32_16x16x32_bf16 v[112:115], a[136:139], v[72:75], v[112:115]
  v_mfma_f32_16x16x32_bf16 v[116:119], a[152:155], v[72:75], v[116:119]
  v_mfma_f32_16x16x32_bf16 v[120:123], a[168:171], v[72:75], v[120:123]
  v_mfma_f32_16x16x32_bf16 v[96:99], a[76:79], v[76:79], v[96:99]
  v_mfma_f32_16x16x32_bf16 v[100:103], a[92:95], v[76:79], v[100:103]
  v_mfma_f32_16x16x32_bf16 v[104:107], a[108:111], v[76:79], v[104:107]
  v_mfma_f32_16x16x32_bf16 v[108:111], a[124:127], v[76:79], v[108:111]
  v_mfma_f32_16x16x32_bf16 v[112:115], a[140:143], v[76:79], v[112:115]
  v_mfma_f32_16x16x32_bf16 v[116:119], a[156:159], v[76:79], v[116:119]
  v_mfma_f32_16x16x32_bf16 v[120:123], a[172:175], v[76:79], v[120:123]
  s_nop 7
  s_mov_b32 s98, 0x00010001
  s_mov_b32 s99, 0x00010001
  s_mov_b64 exec, s[98:99]
  v_and_or_b32 v124, v96, s66, v63
  v_and_or_b32 v125, v97, s66, v63
  v_and_or_b32 v126, v98, s66, v63
  v_and_or_b32 v127, v99, s66, v63
  s_lshl_b64 exec, exec, 1
  v_and_or_b32 v124, v100, s66, v63
  v_and_or_b32 v125, v101, s66, v63
  v_and_or_b32 v126, v102, s66, v63
  v_and_or_b32 v127, v103, s66, v63
  s_lshl_b64 exec, exec, 1
  v_and_or_b32 v124, v104, s66, v63
  v_and_or_b32 v125, v105, s66, v63
  v_and_or_b32 v126, v106, s66, v63
  v_and_or_b32 v127, v107, s66, v63
  s_lshl_b64 exec, exec, 1
  v_and_or_b32 v124, v108, s66, v63
  v_and_or_b32 v125, v109, s66, v63
  v_and_or_b32 v126, v110, s66, v63
  v_and_or_b32 v127, v111, s66, v63
  s_lshl_b64 exec, exec, 1
  v_and_or_b32 v124, v112, s66, v63
  v_and_or_b32 v125, v113, s66, v63
  v_and_or_b32 v126, v114, s66, v63
  v_and_or_b32 v127, v115, s66, v63
  s_lshl_b64 exec, exec, 1
  v_and_or_b32 v124, v116, s66, v63
  v_and_or_b32 v125, v117, s66, v63
  v_and_or_b32 v126, v118, s66, v63
  v_and_or_b32 v127, v119, s66, v63
  s_lshl_b64 exec, exec, 1
  v_and_or_b32 v124, v120, s66, v63
  v_and_or_b32 v125, v121, s66, v63
  v_and_or_b32 v126, v122, s66, v63
  v_and_or_b32 v127, v123, s66, v63
  s_mov_b32 s98, 0x007f007f
  s_mov_b32 s99, 0x007f007f
  s_mov_b64 exec, s[98:99]
  buffer_store_dwordx4 v[124:127], v47, s[36:39], s68 offen sc1
  s_mov_b64 exec, -1
  s_cmp_eq_u32 s3, 0
  s_cbranch_scc0 L_end
  s_cmp_lt_u32 s74, 28
  s_cbranch_scc0 L_end
  v_lshlrev_b32 v46, 11, v44
  v_lshl_add_u32 v46, v45, 4, v46
  s_lshl_b32 s68, s10, 16
  s_lshl_b32 s69, s74, 6
  s_add_u32 s68, s68, s69
  s_add_u32 s68, s68, 2097152
  s_add_u32 s67, s68, 32768
  v_lshlrev_b32 v47, 3, v45
  v_add_u32 v47, 162880, v47
  ds_read_b64 v[92:93], v47
  s_waitcnt lgkmcnt(0)
  v_lshlrev_b32 v100, 16, v92
  v_and_b32 v101, 0xffff0000, v92
  v_lshlrev_b32 v102, 16, v93
  v_and_b32 v103, 0xffff0000, v93
  v_lshlrev_b32 v104, 16, v198
  v_and_b32 v105, 0xffff0000, v198
  v_lshlrev_b32 v106, 16, v199
  v_and_b32 v107, 0xffff0000, v199
  s_mul_i32 s100, s10, 896
  s_lshl_b32 s99, s74, 5
  s_add_u32 s100, s100, s99
  v_lshlrev_b32 v49, 3, v45
  s_mov_b32 s69, 200000
L_sp_9:
  buffer_load_dwordx4 v[64:67], v46, s[36:39], s68 offen sc1
  buffer_load_dwordx4 v[68:71], v46, s[36:39], s67 offen sc1
  s_waitcnt vmcnt(0)
  v_xor_b32 v64, v64, v63
  v_xor_b32 v65, v65, v63
  v_xor_b32 v66, v66, v63
  v_xor_b32 v67, v67, v63
  v_xor_b32 v68, v68, v63
  v_xor_b32 v69, v69, v63
  v_xor_b32 v70, v70, v63
  v_xor_b32 v71, v71, v63
  v_or_b32 v48, v64, v65
  v_or3_b32 v48, v48, v66, v67
  v_or3_b32 v48, v48, v68, v69
  v_or3_b32 v48, v48, v70, v71
  v_and_b32 v48, 0xff, v48
  v_cmp_eq_u32 vcc, 0, v48
  s_nop 1
  s_andn2_b64 exec, exec, vcc
  s_cbranch_scc0 L_spok_10
  s_sub_u32 s69, s69, 1
  s_cmp_eq_u32 s69, 0
  s_cbranch_scc1 L_spok_10
  s_branch L_sp_9
L_spok_10:
  s_mov_b64 exec, -1
  v_add_f32 v108, v64, v68
  v_add_f32 v109, v65, v69
  v_add_f32 v110, v66, v70
  v_add_f32 v111, v67, v71
  s_nop 1
  v_add_f32_dpp v108, v108, v108 row_ror:4 row_mask:0xf bank_mask:0xf
  v_add_f32_dpp v109, v109, v109 row_ror:4 row_mask:0xf bank_mask:0xf
  v_add_f32_dpp v110, v110, v110 row_ror:4 row_mask:0xf bank_mask:0xf
  v_add_f32_dpp v111, v111, v111 row_ror:4 row_mask:0xf bank_mask:0xf
  s_nop 1
  v_add_f32_dpp v108, v108, v108 row_ror:8 row_mask:0xf bank_mask:0xf
  v_add_f32_dpp v109, v109, v109 row_ror:8 row_mask:0xf bank_mask:0xf
  v_add_f32_dpp v110, v110, v110 row_ror:8 row_mask:0xf bank_mask:0xf
  v_add_f32_dpp v111, v111, v111 row_ror:8 row_mask:0xf bank_mask:0xf
  v_mov_b32 v52, v108
  v_mov_b32 v53, v109
  v_mov_b32 v54, v110
  v_mov_b32 v55, v111
  s_nop 1
  v_permlane16_swap_b32 v108, v52
  v_permlane16_swap_b32 v109, v53
  v_permlane16_swap_b32 v110, v54
  v_permlane16_swap_b32 v111, v55
  s_nop 1
  v_add_f32 v108, v108, v52
  v_add_f32 v109, v109, v53
  v_add_f32 v110, v110, v54
  v_add_f32 v111, v111, v55
  v_mov_b32 v52, v108
  v_mov_b32 v53, v109
  v_mov_b32 v54, v110
  v_mov_b32 v55, v111
  s_nop 1
  v_permlane32_swap_b32 v108, v52
  v_permlane32_swap_b32 v109, v53
  v_permlane32_swap_b32 v110, v54
  v_permlane32_swap_b32 v111, v55
  s_nop 1
  v_add_f32 v108, v108, v52
  v_add_f32 v109, v109, v53
  v_add_f32 v110, v110, v54
  v_add_f32 v111, v111, v55
  v_cvt_pk_bf16_f32 v112, v108, v109
  v_cvt_pk_bf16_f32 v113, v110, v111
  v_lshlrev_b32 v108, 16, v112
  v_and_b32 v109, 0xffff0000, v112
  v_lshlrev_b32 v110, 16, v113
  v_and_b32 v111, 0xffff0000, v113
  v_mul_f32 v108, v108, v100
  v_mul_f32 v109, v109, v101
  v_mul_f32 v110, v110, v102
  v_mul_f32 v111, v111, v103
  v_cvt_pk_bf16_f32 v112, v108, v109
  v_cvt_pk_bf16_f32 v113, v110, v111
  v_lshlrev_b32 v108, 16, v112
  v_and_b32 v109, 0xffff0000, v112
  v_lshlrev_b32 v110, 16, v113
  v_and_b32 v111, 0xffff0000, v113
  v_add_f32 v108, v108, v104
  v_add_f32 v109, v109, v105
  v_add_f32 v110, v110, v106
  v_add_f32 v111, v111, v107
  v_cvt_pk_bf16_f32 v112, v108, v109
  v_cvt_pk_bf16_f32 v113, v110, v111
  s_mov_b64 exec, 15
  buffer_store_dwordx2 v[112:113], v49, s[60:63], s100 offen
  s_mov_b64 exec, -1
  s_cmp_eq_u32 s2, 0
  s_cbranch_scc0 L_end
  s_add_u32 s98, s65, 1
  v_mov_b32 v44, s98
  v_mov_b32 v45, 0
  s_mov_b64 exec, 1
  buffer_store_dword v44, v45, s[36:39], 0 offen sc1
  s_mov_b64 exec, -1
L_end:
  s_waitcnt vmcnt(0)
L_done:
  s_endpgm
.section .rodata,"a"
.p2align 6
.amdhsa_kernel recurrent_scan__gqa_block_cached__swiglu_ffn__decode_kernel
  .amdhsa_next_free_vgpr 512
  .amdhsa_next_free_sgpr 102
  .amdhsa_accum_offset 256
  .amdhsa_group_segment_fixed_size 0
  .amdhsa_kernarg_size 96
  .amdhsa_user_sgpr_count 2
  .amdhsa_user_sgpr_kernarg_segment_ptr 1
  .amdhsa_system_sgpr_workgroup_id_x 1
.end_amdhsa_kernel
```
